```python
import torch

def _softmax(x, axis=-1):
    return torch.softmax(x, dim=axis)
def _gelu(x):
    return torch.nn.functional.gelu(x, approximate="tanh")
def _silu(x):
    return torch.nn.functional.silu(x)
def _sigmoid(x):
    return torch.sigmoid(x)
def _layernorm(x, axis=-1, eps=1e-5):
    m = x.mean(dim=axis, keepdim=True)
    v = x.var(dim=axis, keepdim=True, unbiased=False)
    return (x - m) / torch.sqrt(v + eps)
def _scatter_add(tgt, idx, src, axis=0):
    return tgt.clone().index_add_(axis, idx, src)
def _segment_sum(src, seg, n):
    out = torch.zeros((n,) + src.shape[1:], dtype=src.dtype)
    return out.index_add_(0, seg, src)
def _pad(x, pw):
    flat = tuple(v for pair in reversed(pw) for v in pair)
    return torch.nn.functional.pad(x, flat)

kernel_name = 'standalone__layernorm_linear__sampling'

def setup_inputs():

    _w = (lambda a: (lambda t: t.to(torch.bfloat16) if t.is_floating_point() else t)(torch.as_tensor(a)))
    B, S, D = 512, 32, 640
    return {
        "x": _w((lambda *s: torch.randn(*s, dtype=torch.bfloat16) * 0.05)(B, S, D)),
        "g": _w((lambda *s: torch.randn(*s, dtype=torch.bfloat16) * 0.05)(D) + 1.0),
        "b": _w((lambda *s: torch.randn(*s, dtype=torch.bfloat16) * 0.4)(D)),
        "w": _w((lambda *s: torch.randn(*s, dtype=torch.bfloat16) * 0.05)(D, D)),
    }

def reference(x, g, b, w):
    return (_layernorm(x, axis=-1) * g + b) @ w
```

```asm
; @launch grid=(256,1,1) block=(256,1,1) lds=163840
.amdgcn_target "amdgcn-amd-amdhsa--gfx950"
.text
.globl standalone__layernorm_linear__sampling_kernel
.p2align 8
.type standalone__layernorm_linear__sampling_kernel,@function
standalone__layernorm_linear__sampling_kernel:
    s_load_dwordx8 s[4:11], s[0:1], 0
    s_getpc_b64 s[36:37]
L_pc:
    s_and_b32 s38, s2, 8
    s_lshl_b32 s38, s38, 11
    s_nop 0
    v_lshl_add_u32 v253, v0, 6, s38
    v_min_u32 v253, L_end-L_pc, v253
    global_load_dword v254, v253, s[36:37]
    s_cmpk_ge_u32 s2, 0x100
    s_cbranch_scc1 L_end
    s_lshl_b32 s22, 5, 15
    s_lshl_b32 s23, 1, 17
    s_and_b32 s44, s2, 7
    s_lshr_b32 s45, s2, 4
    s_lshl3_add_u32 s44, s45, s44
    s_mul_i32 s56, s44, s22
    v_lshrrev_b32 v243, 4, v0
    v_lshlrev_b32 v4, 4, v0
    v_lshl_add_u32 v1, v243, 10, v4
    s_movk_i32 s57, 20480
    s_waitcnt lgkmcnt(0)
    s_add_u32 s20, s4, s56
    s_addc_u32 s21, s5, 0
    buffer_load_dwordx4 v[144:147], v1, s[20:23], 0 offen nt
    buffer_load_dwordx4 v[148:151], v1, s[20:23], 0 offen offset:256 nt
    buffer_load_dwordx4 v[152:155], v1, s[20:23], 0 offen offset:512 nt
    buffer_load_dwordx4 v[156:159], v1, s[20:23], 0 offen offset:768 nt
    buffer_load_dwordx4 v[160:163], v1, s[20:23], 0 offen offset:1024 nt
    v_lshrrev_b32_e64 v242, 6, v0
    v_and_b32 v4, 0x7f0, v4
    v_readfirstlane_b32 s46, v242
    s_movk_i32 s34, 1280
    s_lshl_b32 s35, 1, 17
    s_cmp_ge_u32 s46, 2
    s_cselect_b32 s32, s8, s6
    s_cselect_b32 s33, s9, s7
    s_lshl_b32 s46, s46, 10
    s_nop 0
    s_add_u32 m0, s46, 122880
    s_load_dwordx2 s[12:13], s[0:1], 32
    buffer_load_dwordx4 v4, s[32:35], 0 offen lds
    v_and_b32_e64 v240, 15, v0
    v_bfe_u32 v241, v0, 4, 2
    v_lshrrev_b32 v252, 2, v240
    v_cmp_eq_u32 vcc, v252, v241
    v_mov_b32 v15, 0x3f803f80
    v_mov_b32 v17, 0
    v_cndmask_b32 v252, v17, v15, vcc
    v_accvgpr_write_b32 a240, v252
    v_accvgpr_write_b32 a241, v252
    v_accvgpr_write_b32 a242, v252
    v_accvgpr_write_b32 a243, v252
    v_and_b32 v15, 2, v240
    v_cmp_eq_u32 vcc, 0, v15
    v_and_b32 v15, 1, v240
    v_lshlrev_b32 v15, 4, v15
    v_mov_b32 v252, 0x3f80
    v_lshlrev_b32_e64 v252, v15, v252
    v_cndmask_b32 v15, v17, v252, vcc
    v_cndmask_b32 v18, v252, v17, vcc
    v_accvgpr_write_b32 a250, v15
    v_accvgpr_write_b32 a251, v18
    buffer_load_dwordx4 v[164:167], v1, s[20:23], s57 offen nt
    buffer_load_dwordx4 v[168:171], v1, s[20:23], s57 offen offset:256 nt
    buffer_load_dwordx4 v[172:175], v1, s[20:23], s57 offen offset:512 nt
    buffer_load_dwordx4 v[176:179], v1, s[20:23], s57 offen offset:768 nt
    buffer_load_dwordx4 v[180:183], v1, s[20:23], s57 offen offset:1024 nt
    v_mov_b32 v250, 0xbacccccd
    v_mov_b32 v251, 0x3acccccd
    v_xor_b32_e64 v15, v243, v240
    v_mul_u32_u24 v252, 1280, v243
    v_lshl_add_u32 v252, v15, 4, v252
    v_add_u32 v3, 81920, v252
    v_lshlrev_b32_e64 v19, 4, v240
    v_add_u32 v19, 122880, v19
    s_waitcnt lgkmcnt(0)
    s_bfe_u32 s47, s2, 65539
    s_mul_i32 s47, s47, 640
    s_mul_i32 s54, s45, 52
    s_lshr_b32 s54, s54, 8
    s_mul_i32 s54, s54, 5
    s_sub_u32 s49, s45, s54
    s_lshl_b32 s49, s49, 7
    s_add_u32 s50, s49, 128
    s_cmp_eq_u32 s50, 640
    s_cselect_b32 s50, 0, s50
    s_add_u32 s48, s50, 128
    s_cmp_eq_u32 s48, 640
    s_cselect_b32 s48, 0, s48
    s_add_u32 s51, s48, 128
    s_cmp_eq_u32 s51, 640
    s_cselect_b32 s51, 0, s51
    s_add_u32 s52, s51, 128
    s_cmp_eq_u32 s52, 640
    s_cselect_b32 s52, 0, s52
    s_add_u32 s24, s10, s49
    s_addc_u32 s25, s11, 0
    s_sub_u32 s26, 819200, s49
    s_lshl_b32 s27, 1, 17
    s_sub_u32 s53, s46, 4096
    s_add_u32 s14, s12, s56
    s_addc_u32 s15, s13, 0
    s_lshl_b32 s31, 1, 17
    s_mov_b32 s72, 40960
    s_mov_b32 s73, 81920
    s_mov_b32 s74, 122880
    s_mov_b32 s75, 163840
    s_mov_b32 s76, 204800
    s_mov_b32 s77, 245760
    s_mov_b32 s78, 286720
    s_mov_b32 s79, 327680
    s_mov_b32 s80, 368640
    s_mov_b32 s81, 409600
    s_mov_b32 s82, 450560
    s_mov_b32 s83, 491520
    s_mov_b32 s84, 532480
    s_mov_b32 s85, 573440
    s_mov_b32 s86, 614400
    s_mov_b32 s87, 655360
    s_mov_b32 s88, 696320
    s_mov_b32 s89, 737280
    s_mov_b32 s90, 778240
    v_and_b32_e64 v243, 1, v242
    v_lshl_add_u32 v243, v243, 4, v240
    v_mul_u32_u24 v252, 1280, v243
    v_add_u32 v252, 81920, v252
    v_add_u32 v15, 0, v241
    v_xor_b32 v15, v15, v240
    v_lshl_add_u32 v5, v15, 4, v252
    v_add_u32 v15, 4, v241
    v_xor_b32 v15, v15, v240
    v_lshl_add_u32 v6, v15, 4, v252
    v_add_u32 v15, 8, v241
    v_xor_b32 v15, v15, v240
    v_lshl_add_u32 v7, v15, 4, v252
    v_add_u32 v15, 12, v241
    v_xor_b32 v15, v15, v240
    v_lshl_add_u32 v8, v15, 4, v252
    v_lshrrev_b32_e64 v243, 3, v0
    v_mul_u32_u24 v252, 1280, v243
    v_and_b32 v15, 1, v241
    v_and_b32 v17, 1, v242
    v_lshl_or_b32 v15, v17, 1, v15
    v_bfe_u32 v17, v0, 1, 2
    v_xor_b32 v15, v15, v17
    v_and_b32 v17, 1, v0
    v_lshl_or_b32 v15, v15, 1, v17
    v_lshl_add_u32 v252, v15, 4, v252
    v_add_u32 v2, s47, v252
    v_lshrrev_b32 v243, 2, v240
    v_lshl_add_u32 v252, v241, 3, v243
    v_lshlrev_b32 v252, 7, v252
    v_and_b32 v15, 3, v0
    v_lshl_add_u32 v252, v15, 3, v252
    v_lshrrev_b32 v243, 1, v243
    v_and_b32 v15, 1, v241
    v_lshl_or_b32 v243, v15, 1, v243
    v_and_b32 v15, 2, v242
    v_xor_b32 v15, v15, v243
    v_lshl_add_u32 v9, v15, 5, v252
    v_xor_b32_e64 v10, 32, v9
    v_add_u32 v11, 65536, v9
    v_add_u32 v244, 122880, v9
    v_add_u32 v12, 65536, v10
    v_add_u32 v245, 122880, v10
    v_bfe_u32 v243, v0, 6, 1
    v_and_b32_e64 v252, 15, v0
    v_lshl_add_u32 v243, v243, 4, v252
    v_mul_u32_u24 v243, 1280, v243
    v_lshrrev_b32_e64 v252, 7, v0
    v_lshl_add_u32 v243, v252, 6, v243
    v_bfe_u32 v252, v0, 4, 1
    v_lshl_add_u32 v243, v252, 5, v243
    v_bfe_u32 v252, v0, 5, 1
    v_lshl_add_u32 v243, v252, 4, v243
    v_add_u32 v16, s47, v243
    v_lshrrev_b32 v17, 6, v0
    v_lshlrev_b32_e64 v17, 12, v17
    v_add_u32 v17, 98304, v17
    v_and_b32_e64 v243, 15, v0
    v_lshl_add_u32 v243, v243, 6, v17
    v_bfe_u32 v252, v0, 4, 1
    v_lshl_add_u32 v243, v252, 3, v243
    v_bfe_u32 v252, v0, 5, 1
    v_bfe_u32 v15, v0, 1, 2
    v_xor_b32_e64 v252, v252, v15
    v_lshl_add_u32 v246, v252, 4, v243
    v_xor_b32_e64 v247, 32, v246
    v_bfe_u32 v15, v0, 2, 4
    v_lshl_add_u32 v243, v15, 6, v17
    v_and_b32_e64 v252, 3, v0
    v_bfe_u32 v17, v0, 3, 2
    v_xor_b32_e64 v17, v17, v252
    v_lshl_add_u32 v248, v17, 4, v243
    v_bfe_u32 v243, v0, 6, 1
    v_lshl_add_u32 v15, v243, 4, v15
    v_mul_u32_u24 v243, 1280, v15
    v_lshl_add_u32 v243, v252, 4, v243
    v_lshrrev_b32_e64 v252, 7, v0
    v_lshl_add_u32 v243, v252, 6, v243
    v_add_u32_e64 v249, s47, v243
    s_mov_b32 s57, 40960
    s_waitcnt vmcnt(10)
    v_mfma_f32_16x16x32_bf16 v[224:227], a[240:243], v[144:147], 0
    buffer_load_dwordx4 v[184:187], v1, s[20:23], s57 offen nt
    s_waitcnt vmcnt(10)
    v_mfma_f32_16x16x32_bf16 v[224:227], a[240:243], v[148:151], v[224:227]
    buffer_load_dwordx4 v[188:191], v1, s[20:23], s57 offen offset:256 nt
    s_waitcnt vmcnt(10)
    v_mfma_f32_16x16x32_bf16 v[224:227], a[240:243], v[152:155], v[224:227]
    buffer_load_dwordx4 v[192:195], v1, s[20:23], s57 offen offset:512 nt
    s_waitcnt vmcnt(10)
    v_mfma_f32_16x16x32_bf16 v[224:227], a[240:243], v[156:159], v[224:227]
    buffer_load_dwordx4 v[196:199], v1, s[20:23], s57 offen offset:768 nt
    s_waitcnt vmcnt(10)
    v_mfma_f32_16x16x32_bf16 v[224:227], a[240:243], v[160:163], v[224:227]
    buffer_load_dwordx4 v[200:203], v1, s[20:23], s57 offen offset:1024 nt
    s_waitcnt vmcnt(10)
    s_barrier
    s_nop 0
    ds_read_b128 v[44:47], v19
    ds_read_b128 v[48:51], v19 offset:256
    ds_read_b128 v[52:55], v19 offset:512
    ds_read_b128 v[56:59], v19 offset:768
    ds_read_b128 v[60:63], v19 offset:1024
    ds_read_b128 v[84:87], v19 offset:2048
    ds_read_b128 v[88:91], v19 offset:2304
    ds_read_b128 v[92:95], v19 offset:2560
    ds_read_b128 v[96:99], v19 offset:2816
    ds_read_b128 v[100:103], v19 offset:3072
    v_add_f32_dpp v224, v224, v224 row_ror:8 row_mask:0xf bank_mask:0xf
    s_nop 1
    v_add_f32_dpp v224, v224, v224 row_ror:4 row_mask:0xf bank_mask:0xf
    s_nop 1
    v_add_f32_dpp v224, v224, v224 row_ror:2 row_mask:0xf bank_mask:0xf
    s_nop 1
    s_nop 0
    v_add_f32_dpp v224, v224, v224 row_ror:1 row_mask:0xf bank_mask:0xf
    v_pk_mul_f32 v[228:229], v[224:225], v[250:251] op_sel_hi:[0,0]
    v_pk_mul_f32 v[230:231], v[224:225], v[250:251] op_sel_hi:[0,0]
    s_waitcnt vmcnt(5)
    s_nop 0
    s_mov_b32 s57, 61440
    v_mfma_f32_16x16x32_bf16 v[224:227], a[240:243], v[164:167], 0
    buffer_load_dwordx4 v[204:207], v1, s[20:23], s57 offen nt
    s_waitcnt lgkmcnt(9)
    v_lshlrev_b32 v24, 16, v44
    v_mfma_f32_16x16x32_bf16 v[224:227], a[240:243], v[168:171], v[224:227]
    buffer_load_dwordx4 v[208:211], v1, s[20:23], s57 offen offset:256 nt
    v_and_b32 v25, 0xffff0000, v44
    v_mfma_f32_16x16x32_bf16 v[224:227], a[240:243], v[172:175], v[224:227]
    buffer_load_dwordx4 v[212:215], v1, s[20:23], s57 offen offset:512 nt
    v_lshlrev_b32_e64 v26, 16, v45
    v_mfma_f32_16x16x32_bf16 v[224:227], a[240:243], v[176:179], v[224:227]
    buffer_load_dwordx4 v[216:219], v1, s[20:23], s57 offen offset:768 nt
    v_and_b32 v27, 0xffff0000, v45
    v_mfma_f32_16x16x32_bf16 v[224:227], a[240:243], v[180:183], v[224:227]
    buffer_load_dwordx4 v[220:223], v1, s[20:23], s57 offen offset:1024 nt
    v_lshlrev_b32_e64 v28, 16, v46
    v_mfma_f32_4x4x4_16b_bf16 v[104:107], a[250:251], v[144:145], v[228:231]
    v_and_b32 v29, 0xffff0000, v46
    v_mfma_f32_4x4x4_16b_bf16 v[108:111], a[250:251], v[146:147], v[228:231]
    v_lshlrev_b32_e64 v30, 16, v47
    v_mfma_f32_4x4x4_16b_bf16 v[112:115], a[250:251], v[148:149], v[228:231]
    v_and_b32 v31, 0xffff0000, v47
    v_mfma_f32_4x4x4_16b_bf16 v[116:119], a[250:251], v[150:151], v[228:231]
    s_waitcnt lgkmcnt(8)
    v_lshlrev_b32 v32, 16, v48
    v_mfma_f32_4x4x4_16b_bf16 v[120:123], a[250:251], v[152:153], v[228:231]
    v_and_b32 v33, 0xffff0000, v48
    v_mfma_f32_4x4x4_16b_bf16 v[124:127], a[250:251], v[154:155], v[228:231]
    v_lshlrev_b32_e64 v34, 16, v49
    v_mfma_f32_4x4x4_16b_bf16 v[128:131], a[250:251], v[156:157], v[228:231]
    v_and_b32 v35, 0xffff0000, v49
    v_mfma_f32_4x4x4_16b_bf16 v[132:135], a[250:251], v[158:159], v[228:231]
    v_lshlrev_b32_e64 v36, 16, v50
    v_mfma_f32_4x4x4_16b_bf16 v[136:139], a[250:251], v[160:161], v[228:231]
    v_and_b32 v37, 0xffff0000, v50
    v_mfma_f32_4x4x4_16b_bf16 v[140:143], a[250:251], v[162:163], v[228:231]
    v_lshlrev_b32_e64 v38, 16, v51
    v_pk_mul_f32 v[20:21], v[104:105], v[104:105]
    v_pk_fma_f32 v[20:21], v[106:107], v[106:107], v[20:21]
    v_add_f32_dpp v224, v224, v224 row_ror:8 row_mask:0xf bank_mask:0xf
    v_pk_fma_f32 v[20:21], v[108:109], v[108:109], v[20:21]
    v_pk_fma_f32 v[20:21], v[110:111], v[110:111], v[20:21]
    v_add_f32_dpp v224, v224, v224 row_ror:4 row_mask:0xf bank_mask:0xf
    v_pk_fma_f32 v[20:21], v[112:113], v[112:113], v[20:21]
    v_pk_fma_f32 v[20:21], v[114:115], v[114:115], v[20:21]
    v_add_f32_dpp v224, v224, v224 row_ror:2 row_mask:0xf bank_mask:0xf
    v_pk_fma_f32 v[20:21], v[116:117], v[116:117], v[20:21]
    v_pk_fma_f32 v[20:21], v[118:119], v[118:119], v[20:21]
    v_add_f32_dpp v224, v224, v224 row_ror:1 row_mask:0xf bank_mask:0xf
    v_pk_fma_f32 v[20:21], v[120:121], v[120:121], v[20:21]
    v_pk_fma_f32 v[20:21], v[122:123], v[122:123], v[20:21]
    v_pk_mul_f32 v[228:229], v[224:225], v[250:251] op_sel_hi:[0,0]
    v_pk_fma_f32 v[20:21], v[124:125], v[124:125], v[20:21]
    v_pk_fma_f32 v[20:21], v[126:127], v[126:127], v[20:21]
    v_pk_mul_f32 v[230:231], v[224:225], v[250:251] op_sel_hi:[0,0]
    v_pk_fma_f32 v[20:21], v[128:129], v[128:129], v[20:21]
    v_pk_fma_f32 v[20:21], v[130:131], v[130:131], v[20:21]
    v_pk_fma_f32 v[20:21], v[132:133], v[132:133], v[20:21]
    v_pk_fma_f32 v[20:21], v[134:135], v[134:135], v[20:21]
    v_pk_fma_f32 v[20:21], v[136:137], v[136:137], v[20:21]
    v_pk_fma_f32 v[20:21], v[138:139], v[138:139], v[20:21]
    v_pk_fma_f32 v[20:21], v[140:141], v[140:141], v[20:21]
    v_pk_fma_f32 v[20:21], v[142:143], v[142:143], v[20:21]
    v_and_b32 v39, 0xffff0000, v51
    s_waitcnt lgkmcnt(7)
    v_lshlrev_b32 v40, 16, v52
    v_and_b32 v41, 0xffff0000, v52
    v_lshlrev_b32_e64 v42, 16, v53
    v_and_b32 v43, 0xffff0000, v53
    v_lshlrev_b32_e64 v44, 16, v54
    v_and_b32 v45, 0xffff0000, v54
    v_lshlrev_b32_e64 v46, 16, v55
    v_and_b32 v47, 0xffff0000, v55
    s_waitcnt lgkmcnt(6)
    v_lshlrev_b32 v48, 16, v56
    v_and_b32 v49, 0xffff0000, v56
    v_lshlrev_b32_e64 v50, 16, v57
    v_and_b32 v51, 0xffff0000, v57
    v_lshlrev_b32_e64 v52, 16, v58
    v_and_b32 v53, 0xffff0000, v58
    v_lshlrev_b32_e64 v54, 16, v59
    v_and_b32 v55, 0xffff0000, v59
    s_waitcnt lgkmcnt(5)
    v_lshlrev_b32 v56, 16, v60
    v_and_b32 v57, 0xffff0000, v60
    v_lshlrev_b32_e64 v58, 16, v61
    v_and_b32 v59, 0xffff0000, v61
    v_lshlrev_b32_e64 v60, 16, v62
    v_and_b32 v61, 0xffff0000, v62
    v_lshlrev_b32_e64 v62, 16, v63
    v_and_b32 v63, 0xffff0000, v63
    s_waitcnt lgkmcnt(4)
    v_lshlrev_b32 v64, 16, v84
    v_and_b32 v65, 0xffff0000, v84
    v_lshlrev_b32_e64 v66, 16, v85
    v_and_b32 v67, 0xffff0000, v85
    v_lshlrev_b32_e64 v68, 16, v86
    v_and_b32 v69, 0xffff0000, v86
    v_lshlrev_b32_e64 v70, 16, v87
    v_and_b32 v71, 0xffff0000, v87
    s_waitcnt lgkmcnt(3)
    v_lshlrev_b32 v72, 16, v88
    v_and_b32 v73, 0xffff0000, v88
    v_lshlrev_b32_e64 v74, 16, v89
    v_and_b32 v75, 0xffff0000, v89
    v_lshlrev_b32_e64 v76, 16, v90
    v_and_b32 v77, 0xffff0000, v90
    v_lshlrev_b32_e64 v78, 16, v91
    v_and_b32 v79, 0xffff0000, v91
    s_waitcnt lgkmcnt(2)
    v_lshlrev_b32 v80, 16, v92
    v_and_b32 v81, 0xffff0000, v92
    v_lshlrev_b32_e64 v82, 16, v93
    v_and_b32 v83, 0xffff0000, v93
    v_lshlrev_b32_e64 v84, 16, v94
    v_and_b32 v85, 0xffff0000, v94
    v_lshlrev_b32_e64 v86, 16, v95
    v_and_b32 v87, 0xffff0000, v95
    s_waitcnt lgkmcnt(1)
    v_lshlrev_b32 v88, 16, v96
    v_and_b32 v89, 0xffff0000, v96
    v_lshlrev_b32_e64 v90, 16, v97
    v_and_b32 v91, 0xffff0000, v97
    v_lshlrev_b32_e64 v92, 16, v98
    v_and_b32 v93, 0xffff0000, v98
    v_lshlrev_b32_e64 v94, 16, v99
    v_and_b32 v95, 0xffff0000, v99
    s_waitcnt lgkmcnt(0)
    v_lshlrev_b32 v96, 16, v100
    v_and_b32 v97, 0xffff0000, v100
    v_lshlrev_b32_e64 v98, 16, v101
    v_and_b32 v99, 0xffff0000, v101
    v_lshlrev_b32_e64 v100, 16, v102
    v_and_b32 v101, 0xffff0000, v102
    v_lshlrev_b32_e64 v102, 16, v103
    v_and_b32 v103, 0xffff0000, v103
    v_add_f32_e64 v18, v20, v21
    v_pk_mul_f32 v[104:105], v[104:105], v[24:25]
    v_pk_mul_f32 v[106:107], v[106:107], v[26:27]
    v_add_f32_dpp v18, v18, v18 row_ror:8 row_mask:0xf bank_mask:0xf
    v_pk_mul_f32 v[108:109], v[108:109], v[28:29]
    v_pk_mul_f32 v[110:111], v[110:111], v[30:31]
    v_add_f32_dpp v18, v18, v18 row_ror:4 row_mask:0xf bank_mask:0xf
    v_pk_mul_f32 v[112:113], v[112:113], v[32:33]
    v_pk_mul_f32 v[114:115], v[114:115], v[34:35]
    v_add_f32_dpp v18, v18, v18 row_ror:2 row_mask:0xf bank_mask:0xf
    v_pk_mul_f32 v[116:117], v[116:117], v[36:37]
    v_pk_mul_f32 v[118:119], v[118:119], v[38:39]
    v_add_f32_dpp v18, v18, v18 row_ror:1 row_mask:0xf bank_mask:0xf
    v_fmaak_f32 v23, v251, v18, 0x3727c5ac
    v_rsq_f32_e64 v22, v23
    v_pk_mul_f32 v[120:121], v[120:121], v[40:41]
    v_pk_mul_f32 v[122:123], v[122:123], v[42:43]
    v_pk_mul_f32 v[124:125], v[124:125], v[44:45]
    v_pk_mul_f32 v[126:127], v[126:127], v[46:47]
    v_pk_mul_f32 v[128:129], v[128:129], v[48:49]
    v_pk_mul_f32 v[130:131], v[130:131], v[50:51]
    v_pk_mul_f32 v[132:133], v[132:133], v[52:53]
    v_pk_mul_f32 v[134:135], v[134:135], v[54:55]
    v_pk_mul_f32 v[136:137], v[136:137], v[56:57]
    v_pk_mul_f32 v[138:139], v[138:139], v[58:59]
    s_mov_b32 s57, 81920
    buffer_load_dwordx4 a[160:163], v1, s[20:23], s57 offen nt
    v_pk_mul_f32 v[140:141], v[140:141], v[60:61]
    v_pk_mul_f32 v[142:143], v[142:143], v[62:63]
    v_pk_fma_f32 v[104:105], v[104:105], v[22:23], v[64:65] op_sel_hi:[1,0,1]
    v_pk_fma_f32 v[106:107], v[106:107], v[22:23], v[66:67] op_sel_hi:[1,0,1]
    v_pk_fma_f32 v[108:109], v[108:109], v[22:23], v[68:69] op_sel_hi:[1,0,1]
    v_pk_fma_f32 v[110:111], v[110:111], v[22:23], v[70:71] op_sel_hi:[1,0,1]
    v_pk_fma_f32 v[112:113], v[112:113], v[22:23], v[72:73] op_sel_hi:[1,0,1]
    v_pk_fma_f32 v[114:115], v[114:115], v[22:23], v[74:75] op_sel_hi:[1,0,1]
    v_pk_fma_f32 v[116:117], v[116:117], v[22:23], v[76:77] op_sel_hi:[1,0,1]
    v_pk_fma_f32 v[118:119], v[118:119], v[22:23], v[78:79] op_sel_hi:[1,0,1]
    v_pk_fma_f32 v[120:121], v[120:121], v[22:23], v[80:81] op_sel_hi:[1,0,1]
    v_pk_fma_f32 v[122:123], v[122:123], v[22:23], v[82:83] op_sel_hi:[1,0,1]
    v_pk_fma_f32 v[124:125], v[124:125], v[22:23], v[84:85] op_sel_hi:[1,0,1]
    v_pk_fma_f32 v[126:127], v[126:127], v[22:23], v[86:87] op_sel_hi:[1,0,1]
    v_pk_fma_f32 v[128:129], v[128:129], v[22:23], v[88:89] op_sel_hi:[1,0,1]
    v_pk_fma_f32 v[130:131], v[130:131], v[22:23], v[90:91] op_sel_hi:[1,0,1]
    v_pk_fma_f32 v[132:133], v[132:133], v[22:23], v[92:93] op_sel_hi:[1,0,1]
    v_pk_fma_f32 v[134:135], v[134:135], v[22:23], v[94:95] op_sel_hi:[1,0,1]
    v_pk_fma_f32 v[136:137], v[136:137], v[22:23], v[96:97] op_sel_hi:[1,0,1]
    v_pk_fma_f32 v[138:139], v[138:139], v[22:23], v[98:99] op_sel_hi:[1,0,1]
    v_pk_fma_f32 v[140:141], v[140:141], v[22:23], v[100:101] op_sel_hi:[1,0,1]
    v_pk_fma_f32 v[142:143], v[142:143], v[22:23], v[102:103] op_sel_hi:[1,0,1]
    v_cvt_pk_bf16_f32 v232, v104, v105
    v_cvt_pk_bf16_f32 v233, v106, v107
    v_cvt_pk_bf16_f32 v234, v108, v109
    v_cvt_pk_bf16_f32 v235, v110, v111
    s_waitcnt vmcnt(6)
    s_nop 0
    v_mfma_f32_16x16x32_bf16 v[224:227], a[240:243], v[184:187], 0
    ds_write_b128 v3, v[232:235]
    v_mfma_f32_4x4x4_16b_bf16 v[104:107], a[250:251], v[164:165], v[228:231]
    buffer_load_dwordx4 a[164:167], v1, s[20:23], s57 offen offset:256 nt
    v_cvt_pk_bf16_f32 v236, v112, v113
    v_mfma_f32_4x4x4_16b_bf16 v[108:111], a[250:251], v[166:167], v[228:231]
    v_cvt_pk_bf16_f32 v237, v114, v115
    v_cvt_pk_bf16_f32 v238, v116, v117
    v_cvt_pk_bf16_f32 v239, v118, v119
    v_mfma_f32_16x16x32_bf16 v[224:227], a[240:243], v[188:191], v[224:227]
    ds_write_b128 v3, v[236:239] offset:256
    v_mfma_f32_4x4x4_16b_bf16 v[112:115], a[250:251], v[168:169], v[228:231]
    buffer_load_dwordx4 a[168:171], v1, s[20:23], s57 offen offset:512 nt
    v_cvt_pk_bf16_f32 v232, v120, v121
    v_mfma_f32_4x4x4_16b_bf16 v[116:119], a[250:251], v[170:171], v[228:231]
    v_cvt_pk_bf16_f32 v233, v122, v123
    v_cvt_pk_bf16_f32 v234, v124, v125
    v_cvt_pk_bf16_f32 v235, v126, v127
    v_mfma_f32_16x16x32_bf16 v[224:227], a[240:243], v[192:195], v[224:227]
    ds_write_b128 v3, v[232:235] offset:512
    v_mfma_f32_4x4x4_16b_bf16 v[120:123], a[250:251], v[172:173], v[228:231]
    buffer_load_dwordx4 a[172:175], v1, s[20:23], s57 offen offset:768 nt
    v_cvt_pk_bf16_f32 v236, v128, v129
    v_mfma_f32_4x4x4_16b_bf16 v[124:127], a[250:251], v[174:175], v[228:231]
    v_cvt_pk_bf16_f32 v237, v130, v131
    v_cvt_pk_bf16_f32 v238, v132, v133
    v_cvt_pk_bf16_f32 v239, v134, v135
    v_mfma_f32_16x16x32_bf16 v[224:227], a[240:243], v[196:199], v[224:227]
    ds_write_b128 v3, v[236:239] offset:768
    v_mfma_f32_4x4x4_16b_bf16 v[128:131], a[250:251], v[176:177], v[228:231]
    buffer_load_dwordx4 a[176:179], v1, s[20:23], s57 offen offset:1024 nt
    v_cvt_pk_bf16_f32 v232, v136, v137
    v_mfma_f32_4x4x4_16b_bf16 v[132:135], a[250:251], v[178:179], v[228:231]
    v_cvt_pk_bf16_f32 v233, v138, v139
    v_cvt_pk_bf16_f32 v234, v140, v141
    v_cvt_pk_bf16_f32 v235, v142, v143
    v_mfma_f32_16x16x32_bf16 v[224:227], a[240:243], v[200:203], v[224:227]
    ds_write_b128 v3, v[232:235] offset:1024
    v_mfma_f32_4x4x4_16b_bf16 v[136:139], a[250:251], v[180:181], v[228:231]
    v_mfma_f32_4x4x4_16b_bf16 v[140:143], a[250:251], v[182:183], v[228:231]
    v_pk_mul_f32 v[20:21], v[104:105], v[104:105]
    v_pk_fma_f32 v[20:21], v[106:107], v[106:107], v[20:21]
    v_pk_fma_f32 v[20:21], v[108:109], v[108:109], v[20:21]
    v_pk_fma_f32 v[20:21], v[110:111], v[110:111], v[20:21]
    v_pk_fma_f32 v[20:21], v[112:113], v[112:113], v[20:21]
    v_pk_fma_f32 v[20:21], v[114:115], v[114:115], v[20:21]
    v_add_f32_dpp v224, v224, v224 row_ror:8 row_mask:0xf bank_mask:0xf
    v_pk_fma_f32 v[20:21], v[116:117], v[116:117], v[20:21]
    v_pk_fma_f32 v[20:21], v[118:119], v[118:119], v[20:21]
    v_add_f32_dpp v224, v224, v224 row_ror:4 row_mask:0xf bank_mask:0xf
    v_pk_fma_f32 v[20:21], v[120:121], v[120:121], v[20:21]
    v_pk_fma_f32 v[20:21], v[122:123], v[122:123], v[20:21]
    v_add_f32_dpp v224, v224, v224 row_ror:2 row_mask:0xf bank_mask:0xf
    v_pk_fma_f32 v[20:21], v[124:125], v[124:125], v[20:21]
    v_pk_fma_f32 v[20:21], v[126:127], v[126:127], v[20:21]
    v_add_f32_dpp v224, v224, v224 row_ror:1 row_mask:0xf bank_mask:0xf
    v_pk_fma_f32 v[20:21], v[128:129], v[128:129], v[20:21]
    v_pk_fma_f32 v[20:21], v[130:131], v[130:131], v[20:21]
    v_pk_mul_f32 v[228:229], v[224:225], v[250:251] op_sel_hi:[0,0]
    v_pk_fma_f32 v[20:21], v[132:133], v[132:133], v[20:21]
    v_pk_fma_f32 v[20:21], v[134:135], v[134:135], v[20:21]
    v_pk_mul_f32 v[230:231], v[224:225], v[250:251] op_sel_hi:[0,0]
    v_pk_fma_f32 v[20:21], v[136:137], v[136:137], v[20:21]
    v_pk_fma_f32 v[20:21], v[138:139], v[138:139], v[20:21]
    v_pk_fma_f32 v[20:21], v[140:141], v[140:141], v[20:21]
    v_pk_fma_f32 v[20:21], v[142:143], v[142:143], v[20:21]
    v_add_f32_e64 v18, v20, v21
    v_pk_mul_f32 v[104:105], v[104:105], v[24:25]
    v_pk_mul_f32 v[106:107], v[106:107], v[26:27]
    v_add_f32_dpp v18, v18, v18 row_ror:8 row_mask:0xf bank_mask:0xf
    v_pk_mul_f32 v[108:109], v[108:109], v[28:29]
    v_pk_mul_f32 v[110:111], v[110:111], v[30:31]
    v_add_f32_dpp v18, v18, v18 row_ror:4 row_mask:0xf bank_mask:0xf
    v_pk_mul_f32 v[112:113], v[112:113], v[32:33]
    v_pk_mul_f32 v[114:115], v[114:115], v[34:35]
    v_add_f32_dpp v18, v18, v18 row_ror:2 row_mask:0xf bank_mask:0xf
    v_pk_mul_f32 v[116:117], v[116:117], v[36:37]
    v_pk_mul_f32 v[118:119], v[118:119], v[38:39]
    v_add_f32_dpp v18, v18, v18 row_ror:1 row_mask:0xf bank_mask:0xf
    v_fmaak_f32 v23, v251, v18, 0x3727c5ac
    v_rsq_f32_e64 v22, v23
    v_pk_mul_f32 v[120:121], v[120:121], v[40:41]
    v_pk_mul_f32 v[122:123], v[122:123], v[42:43]
    v_pk_mul_f32 v[124:125], v[124:125], v[44:45]
    v_pk_mul_f32 v[126:127], v[126:127], v[46:47]
    v_pk_mul_f32 v[128:129], v[128:129], v[48:49]
    v_pk_mul_f32 v[130:131], v[130:131], v[50:51]
    v_pk_mul_f32 v[132:133], v[132:133], v[52:53]
    v_pk_mul_f32 v[134:135], v[134:135], v[54:55]
    v_pk_mul_f32 v[136:137], v[136:137], v[56:57]
    v_pk_mul_f32 v[138:139], v[138:139], v[58:59]
    s_mov_b32 s57, 102400
    buffer_load_dwordx4 a[180:183], v1, s[20:23], s57 offen nt
    v_pk_mul_f32 v[140:141], v[140:141], v[60:61]
    v_pk_mul_f32 v[142:143], v[142:143], v[62:63]
    v_pk_fma_f32 v[104:105], v[104:105], v[22:23], v[64:65] op_sel_hi:[1,0,1]
    v_pk_fma_f32 v[106:107], v[106:107], v[22:23], v[66:67] op_sel_hi:[1,0,1]
    v_pk_fma_f32 v[108:109], v[108:109], v[22:23], v[68:69] op_sel_hi:[1,0,1]
    v_pk_fma_f32 v[110:111], v[110:111], v[22:23], v[70:71] op_sel_hi:[1,0,1]
    v_pk_fma_f32 v[112:113], v[112:113], v[22:23], v[72:73] op_sel_hi:[1,0,1]
    v_pk_fma_f32 v[114:115], v[114:115], v[22:23], v[74:75] op_sel_hi:[1,0,1]
    v_pk_fma_f32 v[116:117], v[116:117], v[22:23], v[76:77] op_sel_hi:[1,0,1]
    v_pk_fma_f32 v[118:119], v[118:119], v[22:23], v[78:79] op_sel_hi:[1,0,1]
    v_pk_fma_f32 v[120:121], v[120:121], v[22:23], v[80:81] op_sel_hi:[1,0,1]
    v_pk_fma_f32 v[122:123], v[122:123], v[22:23], v[82:83] op_sel_hi:[1,0,1]
    v_pk_fma_f32 v[124:125], v[124:125], v[22:23], v[84:85] op_sel_hi:[1,0,1]
    v_pk_fma_f32 v[126:127], v[126:127], v[22:23], v[86:87] op_sel_hi:[1,0,1]
    v_pk_fma_f32 v[128:129], v[128:129], v[22:23], v[88:89] op_sel_hi:[1,0,1]
    v_pk_fma_f32 v[130:131], v[130:131], v[22:23], v[90:91] op_sel_hi:[1,0,1]
    v_pk_fma_f32 v[132:133], v[132:133], v[22:23], v[92:93] op_sel_hi:[1,0,1]
    v_pk_fma_f32 v[134:135], v[134:135], v[22:23], v[94:95] op_sel_hi:[1,0,1]
    v_pk_fma_f32 v[136:137], v[136:137], v[22:23], v[96:97] op_sel_hi:[1,0,1]
    v_pk_fma_f32 v[138:139], v[138:139], v[22:23], v[98:99] op_sel_hi:[1,0,1]
    v_pk_fma_f32 v[140:141], v[140:141], v[22:23], v[100:101] op_sel_hi:[1,0,1]
    v_pk_fma_f32 v[142:143], v[142:143], v[22:23], v[102:103] op_sel_hi:[1,0,1]
    v_cvt_pk_bf16_f32 v232, v104, v105
    v_cvt_pk_bf16_f32 v233, v106, v107
    v_cvt_pk_bf16_f32 v234, v108, v109
    v_cvt_pk_bf16_f32 v235, v110, v111
    s_waitcnt vmcnt(6)
    s_nop 0
    v_mfma_f32_16x16x32_bf16 v[224:227], a[240:243], v[204:207], 0
    ds_write_b128 v3, v[232:235] offset:20480
    v_mfma_f32_4x4x4_16b_bf16 v[104:107], a[250:251], v[184:185], v[228:231]
    buffer_load_dwordx4 a[184:187], v1, s[20:23], s57 offen offset:256 nt
    v_cvt_pk_bf16_f32 v236, v112, v113
    v_mfma_f32_4x4x4_16b_bf16 v[108:111], a[250:251], v[186:187], v[228:231]
    v_cvt_pk_bf16_f32 v237, v114, v115
    v_cvt_pk_bf16_f32 v238, v116, v117
    v_cvt_pk_bf16_f32 v239, v118, v119
    v_mfma_f32_16x16x32_bf16 v[224:227], a[240:243], v[208:211], v[224:227]
    ds_write_b128 v3, v[236:239] offset:20736
    v_mfma_f32_4x4x4_16b_bf16 v[112:115], a[250:251], v[188:189], v[228:231]
    buffer_load_dwordx4 a[188:191], v1, s[20:23], s57 offen offset:512 nt
    v_cvt_pk_bf16_f32 v232, v120, v121
    v_mfma_f32_4x4x4_16b_bf16 v[116:119], a[250:251], v[190:191], v[228:231]
    v_cvt_pk_bf16_f32 v233, v122, v123
    v_cvt_pk_bf16_f32 v234, v124, v125
    v_cvt_pk_bf16_f32 v235, v126, v127
    v_mfma_f32_16x16x32_bf16 v[224:227], a[240:243], v[212:215], v[224:227]
    ds_write_b128 v3, v[232:235] offset:20992
    v_mfma_f32_4x4x4_16b_bf16 v[120:123], a[250:251], v[192:193], v[228:231]
    buffer_load_dwordx4 a[192:195], v1, s[20:23], s57 offen offset:768 nt
    v_cvt_pk_bf16_f32 v236, v128, v129
    v_mfma_f32_4x4x4_16b_bf16 v[124:127], a[250:251], v[194:195], v[228:231]
    v_cvt_pk_bf16_f32 v237, v130, v131
    v_cvt_pk_bf16_f32 v238, v132, v133
    v_cvt_pk_bf16_f32 v239, v134, v135
    v_mfma_f32_16x16x32_bf16 v[224:227], a[240:243], v[216:219], v[224:227]
    ds_write_b128 v3, v[236:239] offset:21248
    v_mfma_f32_4x4x4_16b_bf16 v[128:131], a[250:251], v[196:197], v[228:231]
    buffer_load_dwordx4 a[196:199], v1, s[20:23], s57 offen offset:1024 nt
    v_cvt_pk_bf16_f32 v232, v136, v137
    v_mfma_f32_4x4x4_16b_bf16 v[132:135], a[250:251], v[198:199], v[228:231]
    v_cvt_pk_bf16_f32 v233, v138, v139
    v_cvt_pk_bf16_f32 v234, v140, v141
    v_cvt_pk_bf16_f32 v235, v142, v143
    v_mfma_f32_16x16x32_bf16 v[224:227], a[240:243], v[220:223], v[224:227]
    ds_write_b128 v3, v[232:235] offset:21504
    v_mfma_f32_4x4x4_16b_bf16 v[136:139], a[250:251], v[200:201], v[228:231]
    v_mfma_f32_4x4x4_16b_bf16 v[140:143], a[250:251], v[202:203], v[228:231]
    v_pk_mul_f32 v[20:21], v[104:105], v[104:105]
    v_pk_fma_f32 v[20:21], v[106:107], v[106:107], v[20:21]
    v_pk_fma_f32 v[20:21], v[108:109], v[108:109], v[20:21]
    v_pk_fma_f32 v[20:21], v[110:111], v[110:111], v[20:21]
    v_pk_fma_f32 v[20:21], v[112:113], v[112:113], v[20:21]
    v_pk_fma_f32 v[20:21], v[114:115], v[114:115], v[20:21]
    v_add_f32_dpp v224, v224, v224 row_ror:8 row_mask:0xf bank_mask:0xf
    v_pk_fma_f32 v[20:21], v[116:117], v[116:117], v[20:21]
    v_pk_fma_f32 v[20:21], v[118:119], v[118:119], v[20:21]
    v_add_f32_dpp v224, v224, v224 row_ror:4 row_mask:0xf bank_mask:0xf
    v_pk_fma_f32 v[20:21], v[120:121], v[120:121], v[20:21]
    v_pk_fma_f32 v[20:21], v[122:123], v[122:123], v[20:21]
    v_add_f32_dpp v224, v224, v224 row_ror:2 row_mask:0xf bank_mask:0xf
    v_pk_fma_f32 v[20:21], v[124:125], v[124:125], v[20:21]
    v_pk_fma_f32 v[20:21], v[126:127], v[126:127], v[20:21]
    v_add_f32_dpp v224, v224, v224 row_ror:1 row_mask:0xf bank_mask:0xf
    v_pk_fma_f32 v[20:21], v[128:129], v[128:129], v[20:21]
    v_pk_fma_f32 v[20:21], v[130:131], v[130:131], v[20:21]
    v_pk_mul_f32 v[228:229], v[224:225], v[250:251] op_sel_hi:[0,0]
    v_pk_fma_f32 v[20:21], v[132:133], v[132:133], v[20:21]
    v_pk_fma_f32 v[20:21], v[134:135], v[134:135], v[20:21]
    v_pk_mul_f32 v[230:231], v[224:225], v[250:251] op_sel_hi:[0,0]
    v_pk_fma_f32 v[20:21], v[136:137], v[136:137], v[20:21]
    v_pk_fma_f32 v[20:21], v[138:139], v[138:139], v[20:21]
    v_pk_fma_f32 v[20:21], v[140:141], v[140:141], v[20:21]
    v_pk_fma_f32 v[20:21], v[142:143], v[142:143], v[20:21]
    s_waitcnt lgkmcnt(0)
    s_barrier
    v_add_f32_e64 v18, v20, v21
    v_pk_mul_f32 v[104:105], v[104:105], v[24:25]
    v_pk_mul_f32 v[106:107], v[106:107], v[26:27]
    v_add_f32_dpp v18, v18, v18 row_ror:8 row_mask:0xf bank_mask:0xf
    v_pk_mul_f32 v[108:109], v[108:109], v[28:29]
    v_pk_mul_f32 v[110:111], v[110:111], v[30:31]
    v_add_f32_dpp v18, v18, v18 row_ror:4 row_mask:0xf bank_mask:0xf
    v_pk_mul_f32 v[112:113], v[112:113], v[32:33]
    v_pk_mul_f32 v[114:115], v[114:115], v[34:35]
    v_add_f32_dpp v18, v18, v18 row_ror:2 row_mask:0xf bank_mask:0xf
    v_pk_mul_f32 v[116:117], v[116:117], v[36:37]
    v_pk_mul_f32 v[118:119], v[118:119], v[38:39]
    v_add_f32_dpp v18, v18, v18 row_ror:1 row_mask:0xf bank_mask:0xf
    v_fmaak_f32 v23, v251, v18, 0x3727c5ac
    v_rsq_f32_e64 v22, v23
    v_pk_mul_f32 v[120:121], v[120:121], v[40:41]
    v_pk_mul_f32 v[122:123], v[122:123], v[42:43]
    v_pk_mul_f32 v[124:125], v[124:125], v[44:45]
    v_pk_mul_f32 v[126:127], v[126:127], v[46:47]
    v_pk_mul_f32 v[128:129], v[128:129], v[48:49]
    v_pk_mul_f32 v[130:131], v[130:131], v[50:51]
    v_pk_mul_f32 v[132:133], v[132:133], v[52:53]
    v_pk_mul_f32 v[134:135], v[134:135], v[54:55]
    v_pk_mul_f32 v[136:137], v[136:137], v[56:57]
    v_pk_mul_f32 v[138:139], v[138:139], v[58:59]
    s_mov_b32 s57, 122880
    buffer_load_dwordx4 a[200:203], v1, s[20:23], s57 offen nt
    v_pk_mul_f32 v[140:141], v[140:141], v[60:61]
    v_pk_mul_f32 v[142:143], v[142:143], v[62:63]
    v_pk_fma_f32 v[104:105], v[104:105], v[22:23], v[64:65] op_sel_hi:[1,0,1]
    v_pk_fma_f32 v[106:107], v[106:107], v[22:23], v[66:67] op_sel_hi:[1,0,1]
    v_pk_fma_f32 v[108:109], v[108:109], v[22:23], v[68:69] op_sel_hi:[1,0,1]
    v_pk_fma_f32 v[110:111], v[110:111], v[22:23], v[70:71] op_sel_hi:[1,0,1]
    v_pk_fma_f32 v[112:113], v[112:113], v[22:23], v[72:73] op_sel_hi:[1,0,1]
    v_pk_fma_f32 v[114:115], v[114:115], v[22:23], v[74:75] op_sel_hi:[1,0,1]
    v_pk_fma_f32 v[116:117], v[116:117], v[22:23], v[76:77] op_sel_hi:[1,0,1]
    v_pk_fma_f32 v[118:119], v[118:119], v[22:23], v[78:79] op_sel_hi:[1,0,1]
    v_pk_fma_f32 v[120:121], v[120:121], v[22:23], v[80:81] op_sel_hi:[1,0,1]
    v_pk_fma_f32 v[122:123], v[122:123], v[22:23], v[82:83] op_sel_hi:[1,0,1]
    v_pk_fma_f32 v[124:125], v[124:125], v[22:23], v[84:85] op_sel_hi:[1,0,1]
    v_pk_fma_f32 v[126:127], v[126:127], v[22:23], v[86:87] op_sel_hi:[1,0,1]
    v_pk_fma_f32 v[128:129], v[128:129], v[22:23], v[88:89] op_sel_hi:[1,0,1]
    v_pk_fma_f32 v[130:131], v[130:131], v[22:23], v[90:91] op_sel_hi:[1,0,1]
    v_pk_fma_f32 v[132:133], v[132:133], v[22:23], v[92:93] op_sel_hi:[1,0,1]
    v_pk_fma_f32 v[134:135], v[134:135], v[22:23], v[94:95] op_sel_hi:[1,0,1]
    v_pk_fma_f32 v[136:137], v[136:137], v[22:23], v[96:97] op_sel_hi:[1,0,1]
    v_pk_fma_f32 v[138:139], v[138:139], v[22:23], v[98:99] op_sel_hi:[1,0,1]
    v_pk_fma_f32 v[140:141], v[140:141], v[22:23], v[100:101] op_sel_hi:[1,0,1]
    v_pk_fma_f32 v[142:143], v[142:143], v[22:23], v[102:103] op_sel_hi:[1,0,1]
    s_waitcnt vmcnt(6)
    s_nop 0
    v_mfma_f32_16x16x32_bf16 v[224:227], a[240:243], a[160:163], 0
    ds_read_b128 a[0:3], v5
    ds_read_b128 a[4:7], v6
    ds_read_b128 a[8:11], v7
    ds_read_b128 a[12:15], v8
    ds_read_b128 a[16:19], v5 offset:256
    v_cvt_pk_bf16_f32 v232, v104, v105
    v_cvt_pk_bf16_f32 v233, v106, v107
    v_mfma_f32_16x16x32_bf16 v[224:227], a[240:243], a[164:167], v[224:227]
    ds_read_b128 a[20:23], v6 offset:256
    ds_read_b128 a[24:27], v7 offset:256
    ds_read_b128 a[28:31], v8 offset:256
    ds_read_b128 a[32:35], v5 offset:512
    ds_read_b128 a[36:39], v6 offset:512
    v_cvt_pk_bf16_f32 v234, v108, v109
    v_cvt_pk_bf16_f32 v235, v110, v111
    v_mfma_f32_4x4x4_16b_bf16 v[104:107], a[250:251], v[204:205], v[228:231]
    buffer_load_dwordx4 a[204:207], v1, s[20:23], s57 offen offset:256 nt
    v_cvt_pk_bf16_f32 v236, v112, v113
    v_mfma_f32_4x4x4_16b_bf16 v[108:111], a[250:251], v[206:207], v[228:231]
    v_cvt_pk_bf16_f32 v237, v114, v115
    v_cvt_pk_bf16_f32 v238, v116, v117
    v_cvt_pk_bf16_f32 v239, v118, v119
    v_mfma_f32_16x16x32_bf16 v[224:227], a[240:243], a[168:171], v[224:227]
    ds_write_b128 v3, v[232:235] offset:40960
    v_mfma_f32_4x4x4_16b_bf16 v[112:115], a[250:251], v[208:209], v[228:231]
    buffer_load_dwordx4 a[208:211], v1, s[20:23], s57 offen offset:512 nt
    v_cvt_pk_bf16_f32 v232, v120, v121
    v_mfma_f32_4x4x4_16b_bf16 v[116:119], a[250:251], v[210:211], v[228:231]
    v_cvt_pk_bf16_f32 v233, v122, v123
    v_cvt_pk_bf16_f32 v234, v124, v125
    v_cvt_pk_bf16_f32 v235, v126, v127
    v_mfma_f32_16x16x32_bf16 v[224:227], a[240:243], a[172:175], v[224:227]
    ds_write_b128 v3, v[236:239] offset:41216
    v_mfma_f32_4x4x4_16b_bf16 v[120:123], a[250:251], v[212:213], v[228:231]
    buffer_load_dwordx4 a[212:215], v1, s[20:23], s57 offen offset:768 nt
    v_cvt_pk_bf16_f32 v236, v128, v129
    v_mfma_f32_4x4x4_16b_bf16 v[124:127], a[250:251], v[214:215], v[228:231]
    v_cvt_pk_bf16_f32 v237, v130, v131
    v_cvt_pk_bf16_f32 v238, v132, v133
    v_cvt_pk_bf16_f32 v239, v134, v135
    v_mfma_f32_16x16x32_bf16 v[224:227], a[240:243], a[176:179], v[224:227]
    ds_write_b128 v3, v[232:235] offset:41472
    v_mfma_f32_4x4x4_16b_bf16 v[128:131], a[250:251], v[216:217], v[228:231]
    buffer_load_dwordx4 a[216:219], v1, s[20:23], s57 offen offset:1024 nt
    v_cvt_pk_bf16_f32 v232, v136, v137
    v_mfma_f32_4x4x4_16b_bf16 v[132:135], a[250:251], v[218:219], v[228:231]
    v_cvt_pk_bf16_f32 v233, v138, v139
    v_cvt_pk_bf16_f32 v234, v140, v141
    v_cvt_pk_bf16_f32 v235, v142, v143
    v_mfma_f32_4x4x4_16b_bf16 v[136:139], a[250:251], v[220:221], v[228:231]
    ds_write_b128 v3, v[236:239] offset:41728
    v_mfma_f32_4x4x4_16b_bf16 v[140:143], a[250:251], v[222:223], v[228:231]
    ds_write_b128 v3, v[232:235] offset:41984
    v_pk_mul_f32 v[20:21], v[104:105], v[104:105]
    v_pk_fma_f32 v[20:21], v[106:107], v[106:107], v[20:21]
    v_pk_fma_f32 v[20:21], v[108:109], v[108:109], v[20:21]
    v_pk_fma_f32 v[20:21], v[110:111], v[110:111], v[20:21]
    v_pk_fma_f32 v[20:21], v[112:113], v[112:113], v[20:21]
    v_pk_fma_f32 v[20:21], v[114:115], v[114:115], v[20:21]
    v_add_f32_dpp v224, v224, v224 row_ror:8 row_mask:0xf bank_mask:0xf
    v_pk_fma_f32 v[20:21], v[116:117], v[116:117], v[20:21]
    v_pk_fma_f32 v[20:21], v[118:119], v[118:119], v[20:21]
    v_add_f32_dpp v224, v224, v224 row_ror:4 row_mask:0xf bank_mask:0xf
    v_pk_fma_f32 v[20:21], v[120:121], v[120:121], v[20:21]
    v_pk_fma_f32 v[20:21], v[122:123], v[122:123], v[20:21]
    v_add_f32_dpp v224, v224, v224 row_ror:2 row_mask:0xf bank_mask:0xf
    v_pk_fma_f32 v[20:21], v[124:125], v[124:125], v[20:21]
    v_pk_fma_f32 v[20:21], v[126:127], v[126:127], v[20:21]
    v_add_f32_dpp v224, v224, v224 row_ror:1 row_mask:0xf bank_mask:0xf
    v_pk_fma_f32 v[20:21], v[128:129], v[128:129], v[20:21]
    v_pk_fma_f32 v[20:21], v[130:131], v[130:131], v[20:21]
    v_pk_mul_f32 v[228:229], v[224:225], v[250:251] op_sel_hi:[0,0]
    v_pk_fma_f32 v[20:21], v[132:133], v[132:133], v[20:21]
    v_pk_fma_f32 v[20:21], v[134:135], v[134:135], v[20:21]
    v_pk_mul_f32 v[230:231], v[224:225], v[250:251] op_sel_hi:[0,0]
    v_pk_fma_f32 v[20:21], v[136:137], v[136:137], v[20:21]
    v_pk_fma_f32 v[20:21], v[138:139], v[138:139], v[20:21]
    v_pk_fma_f32 v[20:21], v[140:141], v[140:141], v[20:21]
    v_pk_fma_f32 v[20:21], v[142:143], v[142:143], v[20:21]
    v_add_f32_e64 v18, v20, v21
    v_pk_mul_f32 v[104:105], v[104:105], v[24:25]
    v_pk_mul_f32 v[106:107], v[106:107], v[26:27]
    v_add_f32_dpp v18, v18, v18 row_ror:8 row_mask:0xf bank_mask:0xf
    v_pk_mul_f32 v[108:109], v[108:109], v[28:29]
    v_pk_mul_f32 v[110:111], v[110:111], v[30:31]
    v_add_f32_dpp v18, v18, v18 row_ror:4 row_mask:0xf bank_mask:0xf
    v_pk_mul_f32 v[112:113], v[112:113], v[32:33]
    v_pk_mul_f32 v[114:115], v[114:115], v[34:35]
    v_add_f32_dpp v18, v18, v18 row_ror:2 row_mask:0xf bank_mask:0xf
    v_pk_mul_f32 v[116:117], v[116:117], v[36:37]
    v_pk_mul_f32 v[118:119], v[118:119], v[38:39]
    v_add_f32_dpp v18, v18, v18 row_ror:1 row_mask:0xf bank_mask:0xf
    v_fmaak_f32 v23, v251, v18, 0x3727c5ac
    v_rsq_f32_e64 v22, v23
    v_pk_mul_f32 v[120:121], v[120:121], v[40:41]
    v_pk_mul_f32 v[122:123], v[122:123], v[42:43]
    v_pk_mul_f32 v[124:125], v[124:125], v[44:45]
    v_pk_mul_f32 v[126:127], v[126:127], v[46:47]
    v_pk_mul_f32 v[128:129], v[128:129], v[48:49]
    v_pk_mul_f32 v[130:131], v[130:131], v[50:51]
    v_pk_mul_f32 v[132:133], v[132:133], v[52:53]
    v_pk_mul_f32 v[134:135], v[134:135], v[54:55]
    v_pk_mul_f32 v[136:137], v[136:137], v[56:57]
    v_pk_mul_f32 v[138:139], v[138:139], v[58:59]
    s_mov_b32 s57, 143360
    buffer_load_dwordx4 a[220:223], v1, s[20:23], s57 offen nt
    v_pk_mul_f32 v[140:141], v[140:141], v[60:61]
    v_pk_mul_f32 v[142:143], v[142:143], v[62:63]
    v_pk_fma_f32 v[104:105], v[104:105], v[22:23], v[64:65] op_sel_hi:[1,0,1]
    v_pk_fma_f32 v[106:107], v[106:107], v[22:23], v[66:67] op_sel_hi:[1,0,1]
    v_pk_fma_f32 v[108:109], v[108:109], v[22:23], v[68:69] op_sel_hi:[1,0,1]
    v_pk_fma_f32 v[110:111], v[110:111], v[22:23], v[70:71] op_sel_hi:[1,0,1]
    v_pk_fma_f32 v[112:113], v[112:113], v[22:23], v[72:73] op_sel_hi:[1,0,1]
    v_pk_fma_f32 v[114:115], v[114:115], v[22:23], v[74:75] op_sel_hi:[1,0,1]
    v_pk_fma_f32 v[116:117], v[116:117], v[22:23], v[76:77] op_sel_hi:[1,0,1]
    v_pk_fma_f32 v[118:119], v[118:119], v[22:23], v[78:79] op_sel_hi:[1,0,1]
    v_pk_fma_f32 v[120:121], v[120:121], v[22:23], v[80:81] op_sel_hi:[1,0,1]
    v_pk_fma_f32 v[122:123], v[122:123], v[22:23], v[82:83] op_sel_hi:[1,0,1]
    v_pk_fma_f32 v[124:125], v[124:125], v[22:23], v[84:85] op_sel_hi:[1,0,1]
    v_pk_fma_f32 v[126:127], v[126:127], v[22:23], v[86:87] op_sel_hi:[1,0,1]
    v_pk_fma_f32 v[128:129], v[128:129], v[22:23], v[88:89] op_sel_hi:[1,0,1]
    v_pk_fma_f32 v[130:131], v[130:131], v[22:23], v[90:91] op_sel_hi:[1,0,1]
    v_pk_fma_f32 v[132:133], v[132:133], v[22:23], v[92:93] op_sel_hi:[1,0,1]
    v_pk_fma_f32 v[134:135], v[134:135], v[22:23], v[94:95] op_sel_hi:[1,0,1]
    v_pk_fma_f32 v[136:137], v[136:137], v[22:23], v[96:97] op_sel_hi:[1,0,1]
    v_pk_fma_f32 v[138:139], v[138:139], v[22:23], v[98:99] op_sel_hi:[1,0,1]
    v_pk_fma_f32 v[140:141], v[140:141], v[22:23], v[100:101] op_sel_hi:[1,0,1]
    v_pk_fma_f32 v[142:143], v[142:143], v[22:23], v[102:103] op_sel_hi:[1,0,1]
    s_waitcnt vmcnt(6)
    s_nop 0
    v_mfma_f32_16x16x32_bf16 v[224:227], a[240:243], a[180:183], 0
    ds_read_b128 a[40:43], v7 offset:512
    ds_read_b128 a[44:47], v8 offset:512
    ds_read_b128 a[48:51], v5 offset:768
    ds_read_b128 a[52:55], v6 offset:768
    ds_read_b128 a[56:59], v7 offset:768
    v_cvt_pk_bf16_f32 v232, v104, v105
    v_cvt_pk_bf16_f32 v233, v106, v107
    v_mfma_f32_16x16x32_bf16 v[224:227], a[240:243], a[184:187], v[224:227]
    ds_read_b128 a[60:63], v8 offset:768
    ds_read_b128 a[64:67], v5 offset:1024
    ds_read_b128 a[68:71], v6 offset:1024
    ds_read_b128 a[72:75], v7 offset:1024
    ds_read_b128 a[76:79], v8 offset:1024
    v_cvt_pk_bf16_f32 v234, v108, v109
    v_cvt_pk_bf16_f32 v235, v110, v111
    v_mfma_f32_4x4x4_16b_bf16 v[104:107], a[250:251], a[160:161], v[228:231]
    buffer_load_dwordx4 a[224:227], v1, s[20:23], s57 offen offset:256 nt
    v_cvt_pk_bf16_f32 v236, v112, v113
    v_mfma_f32_4x4x4_16b_bf16 v[108:111], a[250:251], a[162:163], v[228:231]
    v_cvt_pk_bf16_f32 v237, v114, v115
    v_cvt_pk_bf16_f32 v238, v116, v117
    v_cvt_pk_bf16_f32 v239, v118, v119
    v_mfma_f32_16x16x32_bf16 v[224:227], a[240:243], a[188:191], v[224:227]
    ds_write_b128 v3, v[232:235] offset:61440
    v_mfma_f32_4x4x4_16b_bf16 v[112:115], a[250:251], a[164:165], v[228:231]
    buffer_load_dwordx4 a[228:231], v1, s[20:23], s57 offen offset:512 nt
    v_cvt_pk_bf16_f32 v232, v120, v121
    v_mfma_f32_4x4x4_16b_bf16 v[116:119], a[250:251], a[166:167], v[228:231]
    v_cvt_pk_bf16_f32 v233, v122, v123
    v_cvt_pk_bf16_f32 v234, v124, v125
    v_cvt_pk_bf16_f32 v235, v126, v127
    v_mfma_f32_16x16x32_bf16 v[224:227], a[240:243], a[192:195], v[224:227]
    ds_write_b128 v3, v[236:239] offset:61696
    v_mfma_f32_4x4x4_16b_bf16 v[120:123], a[250:251], a[168:169], v[228:231]
    buffer_load_dwordx4 a[232:235], v1, s[20:23], s57 offen offset:768 nt
    v_cvt_pk_bf16_f32 v236, v128, v129
    v_mfma_f32_4x4x4_16b_bf16 v[124:127], a[250:251], a[170:171], v[228:231]
    v_cvt_pk_bf16_f32 v237, v130, v131
    v_cvt_pk_bf16_f32 v238, v132, v133
    v_cvt_pk_bf16_f32 v239, v134, v135
    v_mfma_f32_16x16x32_bf16 v[224:227], a[240:243], a[196:199], v[224:227]
    ds_write_b128 v3, v[232:235] offset:61952
    v_mfma_f32_4x4x4_16b_bf16 v[128:131], a[250:251], a[172:173], v[228:231]
    buffer_load_dwordx4 a[236:239], v1, s[20:23], s57 offen offset:1024 nt
    v_cvt_pk_bf16_f32 v232, v136, v137
    v_mfma_f32_4x4x4_16b_bf16 v[132:135], a[250:251], a[174:175], v[228:231]
    v_cvt_pk_bf16_f32 v233, v138, v139
    v_cvt_pk_bf16_f32 v234, v140, v141
    v_cvt_pk_bf16_f32 v235, v142, v143
    v_mfma_f32_4x4x4_16b_bf16 v[136:139], a[250:251], a[176:177], v[228:231]
    ds_write_b128 v3, v[236:239] offset:62208
    v_mfma_f32_4x4x4_16b_bf16 v[140:143], a[250:251], a[178:179], v[228:231]
    ds_write_b128 v3, v[232:235] offset:62464
    v_pk_mul_f32 v[20:21], v[104:105], v[104:105]
    v_pk_fma_f32 v[20:21], v[106:107], v[106:107], v[20:21]
    v_pk_fma_f32 v[20:21], v[108:109], v[108:109], v[20:21]
    v_pk_fma_f32 v[20:21], v[110:111], v[110:111], v[20:21]
    v_pk_fma_f32 v[20:21], v[112:113], v[112:113], v[20:21]
    v_pk_fma_f32 v[20:21], v[114:115], v[114:115], v[20:21]
    v_add_f32_dpp v224, v224, v224 row_ror:8 row_mask:0xf bank_mask:0xf
    v_pk_fma_f32 v[20:21], v[116:117], v[116:117], v[20:21]
    v_pk_fma_f32 v[20:21], v[118:119], v[118:119], v[20:21]
    v_add_f32_dpp v224, v224, v224 row_ror:4 row_mask:0xf bank_mask:0xf
    v_pk_fma_f32 v[20:21], v[120:121], v[120:121], v[20:21]
    v_pk_fma_f32 v[20:21], v[122:123], v[122:123], v[20:21]
    v_add_f32_dpp v224, v224, v224 row_ror:2 row_mask:0xf bank_mask:0xf
    v_pk_fma_f32 v[20:21], v[124:125], v[124:125], v[20:21]
    v_pk_fma_f32 v[20:21], v[126:127], v[126:127], v[20:21]
    v_add_f32_dpp v224, v224, v224 row_ror:1 row_mask:0xf bank_mask:0xf
    v_pk_fma_f32 v[20:21], v[128:129], v[128:129], v[20:21]
    v_pk_fma_f32 v[20:21], v[130:131], v[130:131], v[20:21]
    v_pk_mul_f32 v[228:229], v[224:225], v[250:251] op_sel_hi:[0,0]
    v_pk_fma_f32 v[20:21], v[132:133], v[132:133], v[20:21]
    v_pk_fma_f32 v[20:21], v[134:135], v[134:135], v[20:21]
    v_pk_mul_f32 v[230:231], v[224:225], v[250:251] op_sel_hi:[0,0]
    v_pk_fma_f32 v[20:21], v[136:137], v[136:137], v[20:21]
    v_pk_fma_f32 v[20:21], v[138:139], v[138:139], v[20:21]
    v_pk_fma_f32 v[20:21], v[140:141], v[140:141], v[20:21]
    v_pk_fma_f32 v[20:21], v[142:143], v[142:143], v[20:21]
    s_waitcnt lgkmcnt(0)
    s_barrier
    v_add_f32_e64 v18, v20, v21
    v_pk_mul_f32 v[104:105], v[104:105], v[24:25]
    v_pk_mul_f32 v[106:107], v[106:107], v[26:27]
    v_add_f32_dpp v18, v18, v18 row_ror:8 row_mask:0xf bank_mask:0xf
    v_pk_mul_f32 v[108:109], v[108:109], v[28:29]
    v_pk_mul_f32 v[110:111], v[110:111], v[30:31]
    v_add_f32_dpp v18, v18, v18 row_ror:4 row_mask:0xf bank_mask:0xf
    v_pk_mul_f32 v[112:113], v[112:113], v[32:33]
    v_pk_mul_f32 v[114:115], v[114:115], v[34:35]
    v_add_f32_dpp v18, v18, v18 row_ror:2 row_mask:0xf bank_mask:0xf
    v_pk_mul_f32 v[116:117], v[116:117], v[36:37]
    v_pk_mul_f32 v[118:119], v[118:119], v[38:39]
    v_add_f32_dpp v18, v18, v18 row_ror:1 row_mask:0xf bank_mask:0xf
    v_fmaak_f32 v23, v251, v18, 0x3727c5ac
    v_rsq_f32_e64 v22, v23
    v_pk_mul_f32 v[120:121], v[120:121], v[40:41]
    v_pk_mul_f32 v[122:123], v[122:123], v[42:43]
    v_pk_mul_f32 v[124:125], v[124:125], v[44:45]
    v_pk_mul_f32 v[126:127], v[126:127], v[46:47]
    v_pk_mul_f32 v[128:129], v[128:129], v[48:49]
    v_pk_mul_f32 v[130:131], v[130:131], v[50:51]
    v_pk_mul_f32 v[132:133], v[132:133], v[52:53]
    v_pk_mul_f32 v[134:135], v[134:135], v[54:55]
    v_pk_mul_f32 v[136:137], v[136:137], v[56:57]
    v_pk_mul_f32 v[138:139], v[138:139], v[58:59]
    v_pk_mul_f32 v[140:141], v[140:141], v[60:61]
    v_pk_mul_f32 v[142:143], v[142:143], v[62:63]
    v_pk_fma_f32 v[104:105], v[104:105], v[22:23], v[64:65] op_sel_hi:[1,0,1]
    v_pk_fma_f32 v[106:107], v[106:107], v[22:23], v[66:67] op_sel_hi:[1,0,1]
    v_pk_fma_f32 v[108:109], v[108:109], v[22:23], v[68:69] op_sel_hi:[1,0,1]
    v_pk_fma_f32 v[110:111], v[110:111], v[22:23], v[70:71] op_sel_hi:[1,0,1]
    v_pk_fma_f32 v[112:113], v[112:113], v[22:23], v[72:73] op_sel_hi:[1,0,1]
    v_pk_fma_f32 v[114:115], v[114:115], v[22:23], v[74:75] op_sel_hi:[1,0,1]
    v_pk_fma_f32 v[116:117], v[116:117], v[22:23], v[76:77] op_sel_hi:[1,0,1]
    v_pk_fma_f32 v[118:119], v[118:119], v[22:23], v[78:79] op_sel_hi:[1,0,1]
    v_pk_fma_f32 v[120:121], v[120:121], v[22:23], v[80:81] op_sel_hi:[1,0,1]
    v_pk_fma_f32 v[122:123], v[122:123], v[22:23], v[82:83] op_sel_hi:[1,0,1]
    v_pk_fma_f32 v[124:125], v[124:125], v[22:23], v[84:85] op_sel_hi:[1,0,1]
    v_pk_fma_f32 v[126:127], v[126:127], v[22:23], v[86:87] op_sel_hi:[1,0,1]
    v_pk_fma_f32 v[128:129], v[128:129], v[22:23], v[88:89] op_sel_hi:[1,0,1]
    v_pk_fma_f32 v[130:131], v[130:131], v[22:23], v[90:91] op_sel_hi:[1,0,1]
    v_pk_fma_f32 v[132:133], v[132:133], v[22:23], v[92:93] op_sel_hi:[1,0,1]
    v_pk_fma_f32 v[134:135], v[134:135], v[22:23], v[94:95] op_sel_hi:[1,0,1]
    v_pk_fma_f32 v[136:137], v[136:137], v[22:23], v[96:97] op_sel_hi:[1,0,1]
    v_pk_fma_f32 v[138:139], v[138:139], v[22:23], v[98:99] op_sel_hi:[1,0,1]
    v_pk_fma_f32 v[140:141], v[140:141], v[22:23], v[100:101] op_sel_hi:[1,0,1]
    v_pk_fma_f32 v[142:143], v[142:143], v[22:23], v[102:103] op_sel_hi:[1,0,1]
    s_waitcnt vmcnt(5)
    s_nop 0
    v_mfma_f32_16x16x32_bf16 v[224:227], a[240:243], a[200:203], 0
    ds_read_b128 a[80:83], v5 offset:40960
    ds_read_b128 a[84:87], v6 offset:40960
    ds_read_b128 a[88:91], v7 offset:40960
    ds_read_b128 a[92:95], v8 offset:40960
    ds_read_b128 a[96:99], v5 offset:41216
    v_cvt_pk_bf16_f32 v232, v104, v105
    v_cvt_pk_bf16_f32 v233, v106, v107
    v_mfma_f32_16x16x32_bf16 v[224:227], a[240:243], a[204:207], v[224:227]
    ds_read_b128 a[100:103], v6 offset:41216
    ds_read_b128 a[104:107], v7 offset:41216
    ds_read_b128 a[108:111], v8 offset:41216
    ds_read_b128 a[112:115], v5 offset:41472
    ds_read_b128 a[116:119], v6 offset:41472
    v_cvt_pk_bf16_f32 v234, v108, v109
    v_cvt_pk_bf16_f32 v235, v110, v111
    s_add_u32 m0, s53, 4096
    v_mfma_f32_4x4x4_16b_bf16 v[104:107], a[250:251], a[180:181], v[228:231]
    buffer_load_dwordx4 v2, s[24:27], 0 offen lds
    v_cvt_pk_bf16_f32 v236, v112, v113
    v_mfma_f32_4x4x4_16b_bf16 v[108:111], a[250:251], a[182:183], v[228:231]
    v_cvt_pk_bf16_f32 v237, v114, v115
    v_cvt_pk_bf16_f32 v238, v116, v117
    v_cvt_pk_bf16_f32 v239, v118, v119
    v_mfma_f32_16x16x32_bf16 v[224:227], a[240:243], a[208:211], v[224:227]
    ds_write_b128 v3, v[232:235]
    s_add_u32 m0, s53, 8192
    v_mfma_f32_4x4x4_16b_bf16 v[112:115], a[250:251], a[184:185], v[228:231]
    buffer_load_dwordx4 v2, s[24:27], s72 offen lds
    v_cvt_pk_bf16_f32 v232, v120, v121
    v_mfma_f32_4x4x4_16b_bf16 v[116:119], a[250:251], a[186:187], v[228:231]
    v_cvt_pk_bf16_f32 v233, v122, v123
    v_cvt_pk_bf16_f32 v234, v124, v125
    v_cvt_pk_bf16_f32 v235, v126, v127
    v_mfma_f32_16x16x32_bf16 v[224:227], a[240:243], a[212:215], v[224:227]
    ds_write_b128 v3, v[236:239] offset:256
    s_add_u32 m0, s53, 12288
    v_mfma_f32_4x4x4_16b_bf16 v[120:123], a[250:251], a[188:189], v[228:231]
    buffer_load_dwordx4 v2, s[24:27], s73 offen lds
    v_cvt_pk_bf16_f32 v236, v128, v129
    v_mfma_f32_4x4x4_16b_bf16 v[124:127], a[250:251], a[190:191], v[228:231]
    v_cvt_pk_bf16_f32 v237, v130, v131
    v_cvt_pk_bf16_f32 v238, v132, v133
    v_cvt_pk_bf16_f32 v239, v134, v135
    v_mfma_f32_16x16x32_bf16 v[224:227], a[240:243], a[216:219], v[224:227]
    ds_write_b128 v3, v[232:235] offset:512
    s_add_u32 m0, s53, 16384
    v_mfma_f32_4x4x4_16b_bf16 v[128:131], a[250:251], a[192:193], v[228:231]
    buffer_load_dwordx4 v2, s[24:27], s74 offen lds
    v_cvt_pk_bf16_f32 v232, v136, v137
    v_mfma_f32_4x4x4_16b_bf16 v[132:135], a[250:251], a[194:195], v[228:231]
    v_cvt_pk_bf16_f32 v233, v138, v139
    v_cvt_pk_bf16_f32 v234, v140, v141
    v_cvt_pk_bf16_f32 v235, v142, v143
    v_mfma_f32_4x4x4_16b_bf16 v[136:139], a[250:251], a[196:197], v[228:231]
    ds_write_b128 v3, v[236:239] offset:768
    s_add_u32 m0, s53, 20480
    v_mfma_f32_4x4x4_16b_bf16 v[140:143], a[250:251], a[198:199], v[228:231]
    buffer_load_dwordx4 v2, s[24:27], s75 offen lds
    ds_write_b128 v3, v[232:235] offset:1024
    v_pk_mul_f32 v[20:21], v[104:105], v[104:105]
    v_pk_fma_f32 v[20:21], v[106:107], v[106:107], v[20:21]
    v_pk_fma_f32 v[20:21], v[108:109], v[108:109], v[20:21]
    v_pk_fma_f32 v[20:21], v[110:111], v[110:111], v[20:21]
    v_pk_fma_f32 v[20:21], v[112:113], v[112:113], v[20:21]
    v_pk_fma_f32 v[20:21], v[114:115], v[114:115], v[20:21]
    v_add_f32_dpp v224, v224, v224 row_ror:8 row_mask:0xf bank_mask:0xf
    v_pk_fma_f32 v[20:21], v[116:117], v[116:117], v[20:21]
    v_pk_fma_f32 v[20:21], v[118:119], v[118:119], v[20:21]
    v_add_f32_dpp v224, v224, v224 row_ror:4 row_mask:0xf bank_mask:0xf
    v_pk_fma_f32 v[20:21], v[120:121], v[120:121], v[20:21]
    v_pk_fma_f32 v[20:21], v[122:123], v[122:123], v[20:21]
    v_add_f32_dpp v224, v224, v224 row_ror:2 row_mask:0xf bank_mask:0xf
    v_pk_fma_f32 v[20:21], v[124:125], v[124:125], v[20:21]
    v_pk_fma_f32 v[20:21], v[126:127], v[126:127], v[20:21]
    v_add_f32_dpp v224, v224, v224 row_ror:1 row_mask:0xf bank_mask:0xf
    v_pk_fma_f32 v[20:21], v[128:129], v[128:129], v[20:21]
    v_pk_fma_f32 v[20:21], v[130:131], v[130:131], v[20:21]
    v_pk_mul_f32 v[228:229], v[224:225], v[250:251] op_sel_hi:[0,0]
    v_pk_fma_f32 v[20:21], v[132:133], v[132:133], v[20:21]
    v_pk_fma_f32 v[20:21], v[134:135], v[134:135], v[20:21]
    v_pk_mul_f32 v[230:231], v[224:225], v[250:251] op_sel_hi:[0,0]
    v_pk_fma_f32 v[20:21], v[136:137], v[136:137], v[20:21]
    v_pk_fma_f32 v[20:21], v[138:139], v[138:139], v[20:21]
    v_pk_fma_f32 v[20:21], v[140:141], v[140:141], v[20:21]
    v_pk_fma_f32 v[20:21], v[142:143], v[142:143], v[20:21]
    v_add_f32_e64 v18, v20, v21
    v_pk_mul_f32 v[104:105], v[104:105], v[24:25]
    v_pk_mul_f32 v[106:107], v[106:107], v[26:27]
    v_add_f32_dpp v18, v18, v18 row_ror:8 row_mask:0xf bank_mask:0xf
    v_pk_mul_f32 v[108:109], v[108:109], v[28:29]
    v_pk_mul_f32 v[110:111], v[110:111], v[30:31]
    v_add_f32_dpp v18, v18, v18 row_ror:4 row_mask:0xf bank_mask:0xf
    v_pk_mul_f32 v[112:113], v[112:113], v[32:33]
    v_pk_mul_f32 v[114:115], v[114:115], v[34:35]
    v_add_f32_dpp v18, v18, v18 row_ror:2 row_mask:0xf bank_mask:0xf
    v_pk_mul_f32 v[116:117], v[116:117], v[36:37]
    v_pk_mul_f32 v[118:119], v[118:119], v[38:39]
    v_add_f32_dpp v18, v18, v18 row_ror:1 row_mask:0xf bank_mask:0xf
    v_fmaak_f32 v23, v251, v18, 0x3727c5ac
    v_rsq_f32_e64 v22, v23
    v_pk_mul_f32 v[120:121], v[120:121], v[40:41]
    v_pk_mul_f32 v[122:123], v[122:123], v[42:43]
    v_pk_mul_f32 v[124:125], v[124:125], v[44:45]
    v_pk_mul_f32 v[126:127], v[126:127], v[46:47]
    v_pk_mul_f32 v[128:129], v[128:129], v[48:49]
    v_pk_mul_f32 v[130:131], v[130:131], v[50:51]
    v_pk_mul_f32 v[132:133], v[132:133], v[52:53]
    v_pk_mul_f32 v[134:135], v[134:135], v[54:55]
    v_pk_mul_f32 v[136:137], v[136:137], v[56:57]
    v_pk_mul_f32 v[138:139], v[138:139], v[58:59]
    v_pk_mul_f32 v[140:141], v[140:141], v[60:61]
    v_pk_mul_f32 v[142:143], v[142:143], v[62:63]
    v_pk_fma_f32 v[104:105], v[104:105], v[22:23], v[64:65] op_sel_hi:[1,0,1]
    v_pk_fma_f32 v[106:107], v[106:107], v[22:23], v[66:67] op_sel_hi:[1,0,1]
    v_pk_fma_f32 v[108:109], v[108:109], v[22:23], v[68:69] op_sel_hi:[1,0,1]
    v_pk_fma_f32 v[110:111], v[110:111], v[22:23], v[70:71] op_sel_hi:[1,0,1]
    v_pk_fma_f32 v[112:113], v[112:113], v[22:23], v[72:73] op_sel_hi:[1,0,1]
    v_pk_fma_f32 v[114:115], v[114:115], v[22:23], v[74:75] op_sel_hi:[1,0,1]
    v_pk_fma_f32 v[116:117], v[116:117], v[22:23], v[76:77] op_sel_hi:[1,0,1]
    v_pk_fma_f32 v[118:119], v[118:119], v[22:23], v[78:79] op_sel_hi:[1,0,1]
    v_pk_fma_f32 v[120:121], v[120:121], v[22:23], v[80:81] op_sel_hi:[1,0,1]
    v_pk_fma_f32 v[122:123], v[122:123], v[22:23], v[82:83] op_sel_hi:[1,0,1]
    v_pk_fma_f32 v[124:125], v[124:125], v[22:23], v[84:85] op_sel_hi:[1,0,1]
    v_pk_fma_f32 v[126:127], v[126:127], v[22:23], v[86:87] op_sel_hi:[1,0,1]
    v_pk_fma_f32 v[128:129], v[128:129], v[22:23], v[88:89] op_sel_hi:[1,0,1]
    v_pk_fma_f32 v[130:131], v[130:131], v[22:23], v[90:91] op_sel_hi:[1,0,1]
    v_pk_fma_f32 v[132:133], v[132:133], v[22:23], v[92:93] op_sel_hi:[1,0,1]
    v_pk_fma_f32 v[134:135], v[134:135], v[22:23], v[94:95] op_sel_hi:[1,0,1]
    v_pk_fma_f32 v[136:137], v[136:137], v[22:23], v[96:97] op_sel_hi:[1,0,1]
    v_pk_fma_f32 v[138:139], v[138:139], v[22:23], v[98:99] op_sel_hi:[1,0,1]
    v_pk_fma_f32 v[140:141], v[140:141], v[22:23], v[100:101] op_sel_hi:[1,0,1]
    v_pk_fma_f32 v[142:143], v[142:143], v[22:23], v[102:103] op_sel_hi:[1,0,1]
    s_waitcnt vmcnt(5)
    s_nop 0
    v_mfma_f32_16x16x32_bf16 v[224:227], a[240:243], a[220:223], 0
    ds_read_b128 a[120:123], v7 offset:41472
    ds_read_b128 a[124:127], v8 offset:41472
    ds_read_b128 a[128:131], v5 offset:41728
    ds_read_b128 a[132:135], v6 offset:41728
    ds_read_b128 a[136:139], v7 offset:41728
    v_cvt_pk_bf16_f32 v232, v104, v105
    v_cvt_pk_bf16_f32 v233, v106, v107
    v_mfma_f32_16x16x32_bf16 v[224:227], a[240:243], a[224:227], v[224:227]
    ds_read_b128 a[140:143], v8 offset:41728
    ds_read_b128 a[144:147], v5 offset:41984
    ds_read_b128 a[148:151], v6 offset:41984
    ds_read_b128 a[152:155], v7 offset:41984
    ds_read_b128 a[156:159], v8 offset:41984
    v_cvt_pk_bf16_f32 v234, v108, v109
    v_cvt_pk_bf16_f32 v235, v110, v111
    s_add_u32 m0, s53, 24576
    v_mfma_f32_4x4x4_16b_bf16 v[104:107], a[250:251], a[200:201], v[228:231]
    buffer_load_dwordx4 v2, s[24:27], s76 offen lds
    v_cvt_pk_bf16_f32 v236, v112, v113
    v_mfma_f32_4x4x4_16b_bf16 v[108:111], a[250:251], a[202:203], v[228:231]
    v_cvt_pk_bf16_f32 v237, v114, v115
    v_cvt_pk_bf16_f32 v238, v116, v117
    v_cvt_pk_bf16_f32 v239, v118, v119
    v_mfma_f32_16x16x32_bf16 v[224:227], a[240:243], a[228:231], v[224:227]
    ds_write_b128 v3, v[232:235] offset:20480
    s_add_u32 m0, s53, 28672
    v_mfma_f32_4x4x4_16b_bf16 v[112:115], a[250:251], a[204:205], v[228:231]
    buffer_load_dwordx4 v2, s[24:27], s77 offen lds
    v_cvt_pk_bf16_f32 v232, v120, v121
    v_mfma_f32_4x4x4_16b_bf16 v[116:119], a[250:251], a[206:207], v[228:231]
    v_cvt_pk_bf16_f32 v233, v122, v123
    v_cvt_pk_bf16_f32 v234, v124, v125
    v_cvt_pk_bf16_f32 v235, v126, v127
    v_mfma_f32_16x16x32_bf16 v[224:227], a[240:243], a[232:235], v[224:227]
    ds_write_b128 v3, v[236:239] offset:20736
    s_add_u32 m0, s53, 32768
    v_mfma_f32_4x4x4_16b_bf16 v[120:123], a[250:251], a[208:209], v[228:231]
    buffer_load_dwordx4 v2, s[24:27], s78 offen lds
    v_cvt_pk_bf16_f32 v236, v128, v129
    v_mfma_f32_4x4x4_16b_bf16 v[124:127], a[250:251], a[210:211], v[228:231]
    v_cvt_pk_bf16_f32 v237, v130, v131
    v_cvt_pk_bf16_f32 v238, v132, v133
    v_cvt_pk_bf16_f32 v239, v134, v135
    v_mfma_f32_16x16x32_bf16 v[224:227], a[240:243], a[236:239], v[224:227]
    ds_write_b128 v3, v[232:235] offset:20992
    s_add_u32 m0, s53, 36864
    v_mfma_f32_4x4x4_16b_bf16 v[128:131], a[250:251], a[212:213], v[228:231]
    buffer_load_dwordx4 v2, s[24:27], s79 offen lds
    v_cvt_pk_bf16_f32 v232, v136, v137
    v_mfma_f32_4x4x4_16b_bf16 v[132:135], a[250:251], a[214:215], v[228:231]
    v_cvt_pk_bf16_f32 v233, v138, v139
    v_cvt_pk_bf16_f32 v234, v140, v141
    v_cvt_pk_bf16_f32 v235, v142, v143
    v_mfma_f32_4x4x4_16b_bf16 v[136:139], a[250:251], a[216:217], v[228:231]
    ds_write_b128 v3, v[236:239] offset:21248
    s_add_u32 m0, s53, 40960
    v_mfma_f32_4x4x4_16b_bf16 v[140:143], a[250:251], a[218:219], v[228:231]
    buffer_load_dwordx4 v2, s[24:27], s80 offen lds
    ds_write_b128 v3, v[232:235] offset:21504
    v_pk_mul_f32 v[20:21], v[104:105], v[104:105]
    v_pk_fma_f32 v[20:21], v[106:107], v[106:107], v[20:21]
    v_pk_fma_f32 v[20:21], v[108:109], v[108:109], v[20:21]
    v_pk_fma_f32 v[20:21], v[110:111], v[110:111], v[20:21]
    v_pk_fma_f32 v[20:21], v[112:113], v[112:113], v[20:21]
    v_pk_fma_f32 v[20:21], v[114:115], v[114:115], v[20:21]
    v_add_f32_dpp v224, v224, v224 row_ror:8 row_mask:0xf bank_mask:0xf
    v_pk_fma_f32 v[20:21], v[116:117], v[116:117], v[20:21]
    v_pk_fma_f32 v[20:21], v[118:119], v[118:119], v[20:21]
    v_add_f32_dpp v224, v224, v224 row_ror:4 row_mask:0xf bank_mask:0xf
    v_pk_fma_f32 v[20:21], v[120:121], v[120:121], v[20:21]
    v_pk_fma_f32 v[20:21], v[122:123], v[122:123], v[20:21]
    v_add_f32_dpp v224, v224, v224 row_ror:2 row_mask:0xf bank_mask:0xf
    v_pk_fma_f32 v[20:21], v[124:125], v[124:125], v[20:21]
    v_pk_fma_f32 v[20:21], v[126:127], v[126:127], v[20:21]
    v_add_f32_dpp v224, v224, v224 row_ror:1 row_mask:0xf bank_mask:0xf
    v_pk_fma_f32 v[20:21], v[128:129], v[128:129], v[20:21]
    v_pk_fma_f32 v[20:21], v[130:131], v[130:131], v[20:21]
    v_pk_mul_f32 v[228:229], v[224:225], v[250:251] op_sel_hi:[0,0]
    v_pk_fma_f32 v[20:21], v[132:133], v[132:133], v[20:21]
    v_pk_fma_f32 v[20:21], v[134:135], v[134:135], v[20:21]
    v_pk_mul_f32 v[230:231], v[224:225], v[250:251] op_sel_hi:[0,0]
    v_pk_fma_f32 v[20:21], v[136:137], v[136:137], v[20:21]
    v_pk_fma_f32 v[20:21], v[138:139], v[138:139], v[20:21]
    v_pk_fma_f32 v[20:21], v[140:141], v[140:141], v[20:21]
    v_pk_fma_f32 v[20:21], v[142:143], v[142:143], v[20:21]
    v_add_f32_e64 v18, v20, v21
    v_pk_mul_f32 v[104:105], v[104:105], v[24:25]
    v_pk_mul_f32 v[106:107], v[106:107], v[26:27]
    v_add_f32_dpp v18, v18, v18 row_ror:8 row_mask:0xf bank_mask:0xf
    v_pk_mul_f32 v[108:109], v[108:109], v[28:29]
    v_pk_mul_f32 v[110:111], v[110:111], v[30:31]
    v_add_f32_dpp v18, v18, v18 row_ror:4 row_mask:0xf bank_mask:0xf
    v_pk_mul_f32 v[112:113], v[112:113], v[32:33]
    v_pk_mul_f32 v[114:115], v[114:115], v[34:35]
    v_add_f32_dpp v18, v18, v18 row_ror:2 row_mask:0xf bank_mask:0xf
    v_pk_mul_f32 v[116:117], v[116:117], v[36:37]
    v_pk_mul_f32 v[118:119], v[118:119], v[38:39]
    v_add_f32_dpp v18, v18, v18 row_ror:1 row_mask:0xf bank_mask:0xf
    v_fmaak_f32 v23, v251, v18, 0x3727c5ac
    v_rsq_f32_e64 v22, v23
    v_pk_mul_f32 v[120:121], v[120:121], v[40:41]
    v_pk_mul_f32 v[122:123], v[122:123], v[42:43]
    v_pk_mul_f32 v[124:125], v[124:125], v[44:45]
    v_pk_mul_f32 v[126:127], v[126:127], v[46:47]
    v_pk_mul_f32 v[128:129], v[128:129], v[48:49]
    v_pk_mul_f32 v[130:131], v[130:131], v[50:51]
    v_pk_mul_f32 v[132:133], v[132:133], v[52:53]
    v_pk_mul_f32 v[134:135], v[134:135], v[54:55]
    v_pk_mul_f32 v[136:137], v[136:137], v[56:57]
    v_pk_mul_f32 v[138:139], v[138:139], v[58:59]
    v_pk_mul_f32 v[140:141], v[140:141], v[60:61]
    v_pk_mul_f32 v[142:143], v[142:143], v[62:63]
    v_pk_fma_f32 v[104:105], v[104:105], v[22:23], v[64:65] op_sel_hi:[1,0,1]
    v_pk_fma_f32 v[106:107], v[106:107], v[22:23], v[66:67] op_sel_hi:[1,0,1]
    v_pk_fma_f32 v[108:109], v[108:109], v[22:23], v[68:69] op_sel_hi:[1,0,1]
    v_pk_fma_f32 v[110:111], v[110:111], v[22:23], v[70:71] op_sel_hi:[1,0,1]
    v_pk_fma_f32 v[112:113], v[112:113], v[22:23], v[72:73] op_sel_hi:[1,0,1]
    v_pk_fma_f32 v[114:115], v[114:115], v[22:23], v[74:75] op_sel_hi:[1,0,1]
    v_pk_fma_f32 v[116:117], v[116:117], v[22:23], v[76:77] op_sel_hi:[1,0,1]
    v_pk_fma_f32 v[118:119], v[118:119], v[22:23], v[78:79] op_sel_hi:[1,0,1]
    v_pk_fma_f32 v[120:121], v[120:121], v[22:23], v[80:81] op_sel_hi:[1,0,1]
    v_pk_fma_f32 v[122:123], v[122:123], v[22:23], v[82:83] op_sel_hi:[1,0,1]
    v_pk_fma_f32 v[124:125], v[124:125], v[22:23], v[84:85] op_sel_hi:[1,0,1]
    v_pk_fma_f32 v[126:127], v[126:127], v[22:23], v[86:87] op_sel_hi:[1,0,1]
    v_pk_fma_f32 v[128:129], v[128:129], v[22:23], v[88:89] op_sel_hi:[1,0,1]
    v_pk_fma_f32 v[130:131], v[130:131], v[22:23], v[90:91] op_sel_hi:[1,0,1]
    v_pk_fma_f32 v[132:133], v[132:133], v[22:23], v[92:93] op_sel_hi:[1,0,1]
    v_pk_fma_f32 v[134:135], v[134:135], v[22:23], v[94:95] op_sel_hi:[1,0,1]
    v_pk_fma_f32 v[136:137], v[136:137], v[22:23], v[96:97] op_sel_hi:[1,0,1]
    v_pk_fma_f32 v[138:139], v[138:139], v[22:23], v[98:99] op_sel_hi:[1,0,1]
    v_pk_fma_f32 v[140:141], v[140:141], v[22:23], v[100:101] op_sel_hi:[1,0,1]
    v_pk_fma_f32 v[142:143], v[142:143], v[22:23], v[102:103] op_sel_hi:[1,0,1]
    s_waitcnt vmcnt(5) lgkmcnt(0)
    s_barrier
    ds_read_b64_tr_b16 v[144:145], v9
    ds_read_b64_tr_b16 v[146:147], v9 offset:512
    ds_read_b64_tr_b16 v[148:149], v9 offset:4096
    ds_read_b64_tr_b16 v[150:151], v9 offset:4608
    ds_read_b64_tr_b16 v[152:153], v9 offset:8192
    ds_read_b64_tr_b16 v[154:155], v9 offset:8704
    ds_read_b64_tr_b16 v[156:157], v9 offset:12288
    ds_read_b64_tr_b16 v[158:159], v9 offset:12800
    ds_read_b64_tr_b16 v[160:161], v9 offset:16384
    ds_read_b64_tr_b16 v[162:163], v9 offset:16896
    v_cvt_pk_bf16_f32 v232, v104, v105
    v_cvt_pk_bf16_f32 v233, v106, v107
    v_cvt_pk_bf16_f32 v234, v108, v109
    v_cvt_pk_bf16_f32 v235, v110, v111
    v_mfma_f32_4x4x4_16b_bf16 v[104:107], a[250:251], a[220:221], v[228:231]
    ds_write_b128 v3, v[232:235] offset:40960
    v_mfma_f32_4x4x4_16b_bf16 v[108:111], a[250:251], a[222:223], v[228:231]
    v_cvt_pk_bf16_f32 v236, v112, v113
    v_cvt_pk_bf16_f32 v237, v114, v115
    v_cvt_pk_bf16_f32 v238, v116, v117
    v_cvt_pk_bf16_f32 v239, v118, v119
    v_mfma_f32_4x4x4_16b_bf16 v[112:115], a[250:251], a[224:225], v[228:231]
    ds_write_b128 v3, v[236:239] offset:41216
    s_add_u32 m0, s53, 45056
    v_mfma_f32_4x4x4_16b_bf16 v[116:119], a[250:251], a[226:227], v[228:231]
    buffer_load_dwordx4 v2, s[24:27], s81 offen lds
    v_cvt_pk_bf16_f32 v232, v120, v121
    v_cvt_pk_bf16_f32 v233, v122, v123
    v_cvt_pk_bf16_f32 v234, v124, v125
    v_cvt_pk_bf16_f32 v235, v126, v127
    v_mfma_f32_4x4x4_16b_bf16 v[120:123], a[250:251], a[228:229], v[228:231]
    ds_write_b128 v3, v[232:235] offset:41472
    s_add_u32 m0, s53, 49152
    v_mfma_f32_4x4x4_16b_bf16 v[124:127], a[250:251], a[230:231], v[228:231]
    buffer_load_dwordx4 v2, s[24:27], s82 offen lds
    v_cvt_pk_bf16_f32 v236, v128, v129
    v_cvt_pk_bf16_f32 v237, v130, v131
    v_cvt_pk_bf16_f32 v238, v132, v133
    v_cvt_pk_bf16_f32 v239, v134, v135
    v_mfma_f32_4x4x4_16b_bf16 v[128:131], a[250:251], a[232:233], v[228:231]
    ds_write_b128 v3, v[236:239] offset:41728
    s_add_u32 m0, s53, 53248
    v_mfma_f32_4x4x4_16b_bf16 v[132:135], a[250:251], a[234:235], v[228:231]
    buffer_load_dwordx4 v2, s[24:27], s83 offen lds
    v_cvt_pk_bf16_f32 v232, v136, v137
    v_cvt_pk_bf16_f32 v233, v138, v139
    v_cvt_pk_bf16_f32 v234, v140, v141
    v_cvt_pk_bf16_f32 v235, v142, v143
    v_mfma_f32_4x4x4_16b_bf16 v[136:139], a[250:251], a[236:237], v[228:231]
    ds_write_b128 v3, v[232:235] offset:41984
    s_add_u32 m0, s53, 57344
    v_mfma_f32_4x4x4_16b_bf16 v[140:143], a[250:251], a[238:239], v[228:231]
    buffer_load_dwordx4 v2, s[24:27], s84 offen lds
    v_pk_mul_f32 v[20:21], v[104:105], v[104:105]
    v_pk_fma_f32 v[20:21], v[106:107], v[106:107], v[20:21]
    v_pk_fma_f32 v[20:21], v[108:109], v[108:109], v[20:21]
    v_pk_fma_f32 v[20:21], v[110:111], v[110:111], v[20:21]
    v_pk_fma_f32 v[20:21], v[112:113], v[112:113], v[20:21]
    v_pk_fma_f32 v[20:21], v[114:115], v[114:115], v[20:21]
    v_pk_fma_f32 v[20:21], v[116:117], v[116:117], v[20:21]
    v_pk_fma_f32 v[20:21], v[118:119], v[118:119], v[20:21]
    v_pk_fma_f32 v[20:21], v[120:121], v[120:121], v[20:21]
    v_pk_fma_f32 v[20:21], v[122:123], v[122:123], v[20:21]
    v_pk_fma_f32 v[20:21], v[124:125], v[124:125], v[20:21]
    v_pk_fma_f32 v[20:21], v[126:127], v[126:127], v[20:21]
    v_pk_fma_f32 v[20:21], v[128:129], v[128:129], v[20:21]
    v_pk_fma_f32 v[20:21], v[130:131], v[130:131], v[20:21]
    v_pk_fma_f32 v[20:21], v[132:133], v[132:133], v[20:21]
    v_pk_fma_f32 v[20:21], v[134:135], v[134:135], v[20:21]
    v_pk_fma_f32 v[20:21], v[136:137], v[136:137], v[20:21]
    v_pk_fma_f32 v[20:21], v[138:139], v[138:139], v[20:21]
    v_pk_fma_f32 v[20:21], v[140:141], v[140:141], v[20:21]
    v_pk_fma_f32 v[20:21], v[142:143], v[142:143], v[20:21]
    v_add_f32_e64 v18, v20, v21
    v_pk_mul_f32 v[104:105], v[104:105], v[24:25]
    v_pk_mul_f32 v[106:107], v[106:107], v[26:27]
    v_add_f32_dpp v18, v18, v18 row_ror:8 row_mask:0xf bank_mask:0xf
    v_pk_mul_f32 v[108:109], v[108:109], v[28:29]
    v_pk_mul_f32 v[110:111], v[110:111], v[30:31]
    v_add_f32_dpp v18, v18, v18 row_ror:4 row_mask:0xf bank_mask:0xf
    v_pk_mul_f32 v[112:113], v[112:113], v[32:33]
    v_pk_mul_f32 v[114:115], v[114:115], v[34:35]
    v_add_f32_dpp v18, v18, v18 row_ror:2 row_mask:0xf bank_mask:0xf
    v_pk_mul_f32 v[116:117], v[116:117], v[36:37]
    v_pk_mul_f32 v[118:119], v[118:119], v[38:39]
    v_add_f32_dpp v18, v18, v18 row_ror:1 row_mask:0xf bank_mask:0xf
    v_fmaak_f32 v23, v251, v18, 0x3727c5ac
    v_rsq_f32_e64 v22, v23
    v_pk_mul_f32 v[120:121], v[120:121], v[40:41]
    v_pk_mul_f32 v[122:123], v[122:123], v[42:43]
    ds_read_b64_tr_b16 v[164:165], v10
    ds_read_b64_tr_b16 v[166:167], v10 offset:512
    ds_read_b64_tr_b16 v[168:169], v10 offset:4096
    v_pk_mul_f32 v[124:125], v[124:125], v[44:45]
    v_pk_mul_f32 v[126:127], v[126:127], v[46:47]
    v_pk_mul_f32 v[128:129], v[128:129], v[48:49]
    v_pk_mul_f32 v[130:131], v[130:131], v[50:51]
    v_pk_mul_f32 v[132:133], v[132:133], v[52:53]
    v_pk_mul_f32 v[134:135], v[134:135], v[54:55]
    ds_read_b64_tr_b16 v[170:171], v10 offset:4608
    ds_read_b64_tr_b16 v[172:173], v10 offset:8192
    ds_read_b64_tr_b16 v[174:175], v10 offset:8704
    v_pk_mul_f32 v[136:137], v[136:137], v[56:57]
    v_pk_mul_f32 v[138:139], v[138:139], v[58:59]
    v_pk_mul_f32 v[140:141], v[140:141], v[60:61]
    v_pk_mul_f32 v[142:143], v[142:143], v[62:63]
    v_pk_fma_f32 v[104:105], v[104:105], v[22:23], v[64:65] op_sel_hi:[1,0,1]
    v_pk_fma_f32 v[106:107], v[106:107], v[22:23], v[66:67] op_sel_hi:[1,0,1]
    ds_read_b64_tr_b16 v[176:177], v10 offset:12288
    ds_read_b64_tr_b16 v[178:179], v10 offset:12800
    ds_read_b64_tr_b16 v[180:181], v10 offset:16384
    v_pk_fma_f32 v[108:109], v[108:109], v[22:23], v[68:69] op_sel_hi:[1,0,1]
    v_pk_fma_f32 v[110:111], v[110:111], v[22:23], v[70:71] op_sel_hi:[1,0,1]
    v_pk_fma_f32 v[112:113], v[112:113], v[22:23], v[72:73] op_sel_hi:[1,0,1]
    v_pk_fma_f32 v[114:115], v[114:115], v[22:23], v[74:75] op_sel_hi:[1,0,1]
    v_pk_fma_f32 v[116:117], v[116:117], v[22:23], v[76:77] op_sel_hi:[1,0,1]
    v_pk_fma_f32 v[118:119], v[118:119], v[22:23], v[78:79] op_sel_hi:[1,0,1]
    ds_read_b64_tr_b16 v[182:183], v10 offset:16896
    ds_read_b128 a[160:163], v5
    ds_read_b128 a[164:167], v6
    v_pk_fma_f32 v[120:121], v[120:121], v[22:23], v[80:81] op_sel_hi:[1,0,1]
    v_pk_fma_f32 v[122:123], v[122:123], v[22:23], v[82:83] op_sel_hi:[1,0,1]
    v_pk_fma_f32 v[124:125], v[124:125], v[22:23], v[84:85] op_sel_hi:[1,0,1]
    v_pk_fma_f32 v[126:127], v[126:127], v[22:23], v[86:87] op_sel_hi:[1,0,1]
    v_pk_fma_f32 v[128:129], v[128:129], v[22:23], v[88:89] op_sel_hi:[1,0,1]
    v_pk_fma_f32 v[130:131], v[130:131], v[22:23], v[90:91] op_sel_hi:[1,0,1]
    ds_read_b128 a[168:171], v7
    ds_read_b128 a[172:175], v8
    ds_read_b128 a[176:179], v5 offset:256
    v_pk_fma_f32 v[132:133], v[132:133], v[22:23], v[92:93] op_sel_hi:[1,0,1]
    v_pk_fma_f32 v[134:135], v[134:135], v[22:23], v[94:95] op_sel_hi:[1,0,1]
    v_pk_fma_f32 v[136:137], v[136:137], v[22:23], v[96:97] op_sel_hi:[1,0,1]
    v_pk_fma_f32 v[138:139], v[138:139], v[22:23], v[98:99] op_sel_hi:[1,0,1]
    v_pk_fma_f32 v[140:141], v[140:141], v[22:23], v[100:101] op_sel_hi:[1,0,1]
    v_pk_fma_f32 v[142:143], v[142:143], v[22:23], v[102:103] op_sel_hi:[1,0,1]
    s_waitcnt lgkmcnt(15)
    s_nop 0
    v_mfma_f32_16x16x32_bf16 v[88:91], v[144:147], a[0:3], 0
    v_cvt_pk_bf16_f32 v232, v104, v105
    v_cvt_pk_bf16_f32 v233, v106, v107
    v_mfma_f32_16x16x32_bf16 v[88:91], v[148:151], a[4:7], v[88:91]
    v_cvt_pk_bf16_f32 v234, v108, v109
    s_add_u32 m0, s53, 61440
    v_mfma_f32_16x16x32_bf16 v[88:91], v[152:155], a[8:11], v[88:91]
    s_waitcnt lgkmcnt(0)
    s_nop 0
    buffer_load_dwordx4 v2, s[24:27], s85 offen lds
    v_cvt_pk_bf16_f32 v235, v110, v111
    v_mfma_f32_16x16x32_bf16 v[88:91], v[156:159], a[12:15], v[88:91]
    ds_write_b128 v3, v[232:235] offset:61440
    v_cvt_pk_bf16_f32 v236, v112, v113
    v_cvt_pk_bf16_f32 v237, v114, v115
    v_mfma_f32_16x16x32_bf16 v[88:91], v[160:163], a[16:19], v[88:91]
    v_cvt_pk_bf16_f32 v238, v116, v117
    v_cvt_pk_bf16_f32 v239, v118, v119
    v_mfma_f32_16x16x32_bf16 v[96:99], v[144:147], a[80:83], 0
    ds_write_b128 v3, v[236:239] offset:61696
    s_add_u32 m0, s53, 65536
    v_cvt_pk_bf16_f32 v232, v120, v121
    v_cvt_pk_bf16_f32 v233, v122, v123
    v_mfma_f32_16x16x32_bf16 v[96:99], v[148:151], a[84:87], v[96:99]
    buffer_load_dwordx4 v2, s[24:27], s86 offen lds
    v_cvt_pk_bf16_f32 v234, v124, v125
    v_cvt_pk_bf16_f32 v235, v126, v127
    v_mfma_f32_16x16x32_bf16 v[96:99], v[152:155], a[88:91], v[96:99]
    ds_write_b128 v3, v[232:235] offset:61952
    v_cvt_pk_bf16_f32 v236, v128, v129
    v_cvt_pk_bf16_f32 v237, v130, v131
    v_mfma_f32_16x16x32_bf16 v[96:99], v[156:159], a[92:95], v[96:99]
    v_cvt_pk_bf16_f32 v238, v132, v133
    s_add_u32 m0, s53, 69632
    v_cvt_pk_bf16_f32 v239, v134, v135
    ds_write_b128 v3, v[236:239] offset:62208
    v_cvt_pk_bf16_f32 v232, v136, v137
    v_mfma_f32_16x16x32_bf16 v[96:99], v[160:163], a[96:99], v[96:99]
    buffer_load_dwordx4 v2, s[24:27], s87 offen lds
    v_cvt_pk_bf16_f32 v233, v138, v139
    v_mfma_f32_16x16x32_bf16 v[92:95], v[164:167], a[0:3], 0
    v_cvt_pk_bf16_f32 v234, v140, v141
    v_cvt_pk_bf16_f32 v235, v142, v143
    v_mfma_f32_16x16x32_bf16 v[92:95], v[168:171], a[4:7], v[92:95]
    ds_write_b128 v3, v[232:235] offset:62464
    s_add_u32 m0, s53, 73728
    v_mfma_f32_16x16x32_bf16 v[92:95], v[172:175], a[8:11], v[92:95]
    buffer_load_dwordx4 v2, s[24:27], s88 offen lds
    v_mfma_f32_16x16x32_bf16 v[92:95], v[176:179], a[12:15], v[92:95]
    s_add_u32 m0, s53, 77824
    v_mfma_f32_16x16x32_bf16 v[92:95], v[180:183], a[16:19], v[92:95]
    buffer_load_dwordx4 v2, s[24:27], s89 offen lds
    v_mfma_f32_16x16x32_bf16 v[100:103], v[164:167], a[80:83], 0
    s_waitcnt vmcnt(9) lgkmcnt(0)
    s_barrier
    s_add_u32 m0, s53, 81920
    v_mfma_f32_16x16x32_bf16 v[100:103], v[168:171], a[84:87], v[100:103]
    buffer_load_dwordx4 v2, s[24:27], s90 offen lds
    ds_read_b64_tr_b16 v[204:205], v9 offset:20480
    ds_read_b64_tr_b16 v[206:207], v9 offset:20992
    ds_read_b64_tr_b16 v[208:209], v9 offset:24576
    ds_read_b64_tr_b16 v[210:211], v9 offset:25088
    ds_read_b64_tr_b16 v[212:213], v9 offset:28672
    ds_read_b64_tr_b16 v[214:215], v9 offset:29184
    v_mfma_f32_16x16x32_bf16 v[100:103], v[172:175], a[88:91], v[100:103]
    ds_read_b128 a[240:243], v5 offset:40960
    v_mfma_f32_16x16x32_bf16 v[100:103], v[176:179], a[92:95], v[100:103]
    ds_read_b128 a[244:247], v6 offset:40960
    v_mfma_f32_16x16x32_bf16 v[100:103], v[180:183], a[96:99], v[100:103]
    ds_read_b128 a[248:251], v7 offset:40960
    v_mfma_f32_16x16x32_bf16 v[104:107], v[144:147], a[160:163], 0
    ds_read_b128 a[252:255], v8 offset:40960
    v_mfma_f32_16x16x32_bf16 v[104:107], v[148:151], a[164:167], v[104:107]
    ds_read_b128 v[24:27], v5 offset:41216
    v_mfma_f32_16x16x32_bf16 v[104:107], v[152:155], a[168:171], v[104:107]
    ds_read_b64_tr_b16 v[216:217], v9 offset:32768
    v_mfma_f32_16x16x32_bf16 v[104:107], v[156:159], a[172:175], v[104:107]
    ds_read_b64_tr_b16 v[218:219], v9 offset:33280
    v_mfma_f32_16x16x32_bf16 v[104:107], v[160:163], a[176:179], v[104:107]
    ds_read_b64_tr_b16 v[220:221], v9 offset:36864
    v_mfma_f32_16x16x32_bf16 v[108:111], v[164:167], a[160:163], 0
    ds_read_b64_tr_b16 v[222:223], v9 offset:37376
    v_mfma_f32_16x16x32_bf16 v[108:111], v[168:171], a[164:167], v[108:111]
    ds_read_b64_tr_b16 v[224:225], v10 offset:20480
    v_mfma_f32_16x16x32_bf16 v[108:111], v[172:175], a[168:171], v[108:111]
    ds_read_b64_tr_b16 v[226:227], v10 offset:20992
    v_mfma_f32_16x16x32_bf16 v[108:111], v[176:179], a[172:175], v[108:111]
    ds_read_b64_tr_b16 v[228:229], v10 offset:24576
    v_mfma_f32_16x16x32_bf16 v[108:111], v[180:183], a[176:179], v[108:111]
    s_waitcnt lgkmcnt(7)
    s_nop 0
    ds_read_b64_tr_b16 v[230:231], v10 offset:25088
    v_mfma_f32_16x16x32_bf16 v[112:115], v[144:147], a[240:243], 0
    ds_read_b64_tr_b16 v[232:233], v10 offset:28672
    v_mfma_f32_16x16x32_bf16 v[112:115], v[148:151], a[244:247], v[112:115]
    ds_read_b64_tr_b16 v[234:235], v10 offset:29184
    v_mfma_f32_16x16x32_bf16 v[112:115], v[152:155], a[248:251], v[112:115]
    ds_read_b64_tr_b16 v[236:237], v10 offset:32768
    v_mfma_f32_16x16x32_bf16 v[112:115], v[156:159], a[252:255], v[112:115]
    ds_read_b64_tr_b16 v[238:239], v10 offset:33280
    v_mfma_f32_16x16x32_bf16 v[112:115], v[160:163], v[24:27], v[112:115]
    ds_read_b64_tr_b16 v[240:241], v10 offset:36864
    v_mfma_f32_16x16x32_bf16 v[116:119], v[164:167], a[240:243], 0
    ds_read_b64_tr_b16 v[242:243], v10 offset:37376
    v_mfma_f32_16x16x32_bf16 v[116:119], v[168:171], a[244:247], v[116:119]
    v_mfma_f32_16x16x32_bf16 v[116:119], v[172:175], a[248:251], v[116:119]
    v_mfma_f32_16x16x32_bf16 v[116:119], v[176:179], a[252:255], v[116:119]
    s_waitcnt vmcnt(5) lgkmcnt(0)
    s_barrier
    v_mfma_f32_16x16x32_bf16 v[116:119], v[180:183], v[24:27], v[116:119]
    v_mfma_f32_16x16x32_bf16 v[88:91], v[204:207], a[20:23], v[88:91]
    ds_read_b128 a[180:183], v6 offset:256
    ds_read_b64_tr_b16 v[144:145], v9 offset:40960
    ds_read_b64_tr_b16 v[146:147], v9 offset:41472
    ds_read_b64_tr_b16 v[148:149], v9 offset:45056
    ds_read_b64_tr_b16 v[150:151], v9 offset:45568
    v_mfma_f32_16x16x32_bf16 v[88:91], v[208:211], a[24:27], v[88:91]
    ds_read_b128 a[184:187], v7 offset:256
    s_add_u32 s24, s10, s50
    s_addc_u32 s25, s11, 0
    v_mfma_f32_16x16x32_bf16 v[88:91], v[212:215], a[28:31], v[88:91]
    ds_read_b128 a[188:191], v8 offset:256
    s_sub_u32 s26, 819200, s50
    v_mfma_f32_16x16x32_bf16 v[88:91], v[216:219], a[32:35], v[88:91]
    ds_read_b128 a[192:195], v5 offset:512
    s_add_u32 m0, s53, 4096
    v_mfma_f32_16x16x32_bf16 v[88:91], v[220:223], a[36:39], v[88:91]
    buffer_load_dwordx4 v2, s[24:27], 0 offen lds
    v_mfma_f32_16x16x32_bf16 v[92:95], v[224:227], a[20:23], v[92:95]
    ds_read_b128 a[196:199], v6 offset:512
    s_add_u32 m0, s53, 8192
    v_mfma_f32_16x16x32_bf16 v[92:95], v[228:231], a[24:27], v[92:95]
    buffer_load_dwordx4 v2, s[24:27], s72 offen lds
    v_mfma_f32_16x16x32_bf16 v[92:95], v[232:235], a[28:31], v[92:95]
    ds_read_b128 v[28:31], v6 offset:41216
    s_add_u32 m0, s53, 12288
    v_mfma_f32_16x16x32_bf16 v[92:95], v[236:239], a[32:35], v[92:95]
    buffer_load_dwordx4 v2, s[24:27], s73 offen lds
    v_mfma_f32_16x16x32_bf16 v[92:95], v[240:243], a[36:39], v[92:95]
    ds_read_b128 v[32:35], v7 offset:41216
    s_add_u32 m0, s53, 16384
    v_mfma_f32_16x16x32_bf16 v[96:99], v[204:207], a[100:103], v[96:99]
    ds_read_b128 v[36:39], v8 offset:41216
    v_mfma_f32_16x16x32_bf16 v[96:99], v[208:211], a[104:107], v[96:99]
    buffer_load_dwordx4 v2, s[24:27], s74 offen lds
    v_mfma_f32_16x16x32_bf16 v[96:99], v[212:215], a[108:111], v[96:99]
    ds_read_b128 v[40:43], v5 offset:41472
    s_add_u32 m0, s53, 20480
    v_mfma_f32_16x16x32_bf16 v[96:99], v[216:219], a[112:115], v[96:99]
    ds_read_b128 v[44:47], v6 offset:41472
    v_mfma_f32_16x16x32_bf16 v[96:99], v[220:223], a[116:119], v[96:99]
    buffer_load_dwordx4 v2, s[24:27], s75 offen lds
    v_mfma_f32_16x16x32_bf16 v[100:103], v[224:227], a[100:103], v[100:103]
    ds_read_b64_tr_b16 v[152:153], v9 offset:49152
    s_add_u32 m0, s53, 24576
    v_mfma_f32_16x16x32_bf16 v[100:103], v[228:231], a[104:107], v[100:103]
    ds_read_b64_tr_b16 v[154:155], v9 offset:49664
    v_mfma_f32_16x16x32_bf16 v[100:103], v[232:235], a[108:111], v[100:103]
    buffer_load_dwordx4 v2, s[24:27], s76 offen lds
    v_mfma_f32_16x16x32_bf16 v[100:103], v[236:239], a[112:115], v[100:103]
    ds_read_b64_tr_b16 v[156:157], v9 offset:53248
    s_add_u32 m0, s53, 28672
    v_mfma_f32_16x16x32_bf16 v[100:103], v[240:243], a[116:119], v[100:103]
    s_waitcnt lgkmcnt(8)
    s_nop 0
    ds_read_b64_tr_b16 v[158:159], v9 offset:53760
    v_mfma_f32_16x16x32_bf16 v[104:107], v[204:207], a[180:183], v[104:107]
    buffer_load_dwordx4 v2, s[24:27], s77 offen lds
    v_mfma_f32_16x16x32_bf16 v[104:107], v[208:211], a[184:187], v[104:107]
    ds_read_b64_tr_b16 v[160:161], v9 offset:57344
    s_add_u32 m0, s53, 32768
    v_mfma_f32_16x16x32_bf16 v[104:107], v[212:215], a[188:191], v[104:107]
    ds_read_b64_tr_b16 v[162:163], v9 offset:57856
    v_mfma_f32_16x16x32_bf16 v[104:107], v[216:219], a[192:195], v[104:107]
    buffer_load_dwordx4 v2, s[24:27], s78 offen lds
    v_mfma_f32_16x16x32_bf16 v[104:107], v[220:223], a[196:199], v[104:107]
    ds_read_b64_tr_b16 v[164:165], v10 offset:40960
    s_add_u32 m0, s53, 36864
    v_mfma_f32_16x16x32_bf16 v[108:111], v[224:227], a[180:183], v[108:111]
    ds_read_b64_tr_b16 v[166:167], v10 offset:41472
    v_mfma_f32_16x16x32_bf16 v[108:111], v[228:231], a[184:187], v[108:111]
    buffer_load_dwordx4 v2, s[24:27], s79 offen lds
    v_mfma_f32_16x16x32_bf16 v[108:111], v[232:235], a[188:191], v[108:111]
    ds_read_b64_tr_b16 v[168:169], v10 offset:45056
    s_add_u32 m0, s53, 40960
    v_mfma_f32_16x16x32_bf16 v[108:111], v[236:239], a[192:195], v[108:111]
    ds_read_b64_tr_b16 v[170:171], v10 offset:45568
    v_mfma_f32_16x16x32_bf16 v[108:111], v[240:243], a[196:199], v[108:111]
    s_waitcnt lgkmcnt(10)
    s_nop 0
    buffer_load_dwordx4 v2, s[24:27], s80 offen lds
    v_mfma_f32_16x16x32_bf16 v[112:115], v[204:207], v[28:31], v[112:115]
    ds_read_b64_tr_b16 v[172:173], v10 offset:49152
    v_mfma_f32_16x16x32_bf16 v[112:115], v[208:211], v[32:35], v[112:115]
    ds_read_b64_tr_b16 v[174:175], v10 offset:49664
    v_mfma_f32_16x16x32_bf16 v[112:115], v[212:215], v[36:39], v[112:115]
    ds_read_b64_tr_b16 v[176:177], v10 offset:53248
    v_mfma_f32_16x16x32_bf16 v[112:115], v[216:219], v[40:43], v[112:115]
    ds_read_b64_tr_b16 v[178:179], v10 offset:53760
    v_mfma_f32_16x16x32_bf16 v[112:115], v[220:223], v[44:47], v[112:115]
    ds_read_b64_tr_b16 v[180:181], v10 offset:57344
    v_mfma_f32_16x16x32_bf16 v[116:119], v[224:227], v[28:31], v[116:119]
    ds_read_b64_tr_b16 v[182:183], v10 offset:57856
    v_mfma_f32_16x16x32_bf16 v[116:119], v[228:231], v[32:35], v[116:119]
    v_mfma_f32_16x16x32_bf16 v[116:119], v[232:235], v[36:39], v[116:119]
    v_mfma_f32_16x16x32_bf16 v[116:119], v[236:239], v[40:43], v[116:119]
    s_waitcnt vmcnt(10) lgkmcnt(0)
    s_barrier
    v_mfma_f32_16x16x32_bf16 v[116:119], v[240:243], v[44:47], v[116:119]
    v_mfma_f32_16x16x32_bf16 v[88:91], v[144:147], a[40:43], v[88:91]
    ds_read_b128 a[200:203], v7 offset:512
    s_add_u32 m0, s53, 45056
    v_mfma_f32_16x16x32_bf16 v[88:91], v[148:151], a[44:47], v[88:91]
    ds_read_b128 a[204:207], v8 offset:512
    v_mfma_f32_16x16x32_bf16 v[88:91], v[152:155], a[48:51], v[88:91]
    buffer_load_dwordx4 v2, s[24:27], s81 offen lds
    v_mfma_f32_16x16x32_bf16 v[88:91], v[156:159], a[52:55], v[88:91]
    ds_read_b128 a[208:211], v5 offset:768
    v_mfma_f32_16x16x32_bf16 v[88:91], v[160:163], a[56:59], v[88:91]
    ds_read_b128 a[212:215], v6 offset:768
    v_mfma_f32_16x16x32_bf16 v[92:95], v[164:167], a[40:43], v[92:95]
    ds_read_b128 a[216:219], v7 offset:768
    v_mfma_f32_16x16x32_bf16 v[92:95], v[168:171], a[44:47], v[92:95]
    ds_read_b128 v[48:51], v7 offset:41472
    v_mfma_f32_16x16x32_bf16 v[92:95], v[172:175], a[48:51], v[92:95]
    ds_read_b128 v[52:55], v8 offset:41472
    s_add_u32 m0, s53, 49152
    v_mfma_f32_16x16x32_bf16 v[92:95], v[176:179], a[52:55], v[92:95]
    ds_read_b128 v[56:59], v5 offset:41728
    v_mfma_f32_16x16x32_bf16 v[92:95], v[180:183], a[56:59], v[92:95]
    buffer_load_dwordx4 v2, s[24:27], s82 offen lds
    v_mfma_f32_16x16x32_bf16 v[96:99], v[144:147], a[120:123], v[96:99]
    ds_read_b128 v[60:63], v6 offset:41728
    s_mov_b32 s44, 0
    s_nop 0
    v_mfma_f32_16x16x32_bf16 v[96:99], v[148:151], a[124:127], v[96:99]
    ds_read_b128 v[64:67], v7 offset:41728
    s_mov_b32 s45, 40960
    v_mfma_f32_16x16x32_bf16 v[96:99], v[152:155], a[128:131], v[96:99]
    ds_read_b64_tr_b16 v[204:205], v9 offset:61440
    s_mov_b32 s57, 122880
    v_mfma_f32_16x16x32_bf16 v[96:99], v[156:159], a[132:135], v[96:99]
    ds_read_b64_tr_b16 v[206:207], v9 offset:61952
    s_mov_b32 s3, s51
    s_nop 0
    v_mfma_f32_16x16x32_bf16 v[96:99], v[160:163], a[136:139], v[96:99]
    ds_read_b64_tr_b16 v[208:209], v11
    s_add_u32 m0, s53, 53248
    v_mfma_f32_16x16x32_bf16 v[100:103], v[164:167], a[120:123], v[100:103]
    ds_read_b64_tr_b16 v[210:211], v11 offset:512
    s_mov_b32 s38, s49
    s_nop 0
    v_mfma_f32_16x16x32_bf16 v[100:103], v[168:171], a[124:127], v[100:103]
    buffer_load_dwordx4 v2, s[24:27], s83 offen lds
    v_mfma_f32_16x16x32_bf16 v[100:103], v[172:175], a[128:131], v[100:103]
    ds_read_b64_tr_b16 v[212:213], v11 offset:4096
    s_mov_b32 s55, 0
    v_mfma_f32_16x16x32_bf16 v[100:103], v[176:179], a[132:135], v[100:103]
    ds_read_b64_tr_b16 v[214:215], v11 offset:4608
    v_mov_b32 v13, v9
    v_mfma_f32_16x16x32_bf16 v[100:103], v[180:183], a[136:139], v[100:103]
    s_waitcnt lgkmcnt(11)
    ds_read_b64_tr_b16 v[216:217], v11 offset:8192
    v_mov_b32 v14, v10
    v_mfma_f32_16x16x32_bf16 v[104:107], v[144:147], a[200:203], v[104:107]
    ds_read_b64_tr_b16 v[218:219], v11 offset:8704
    v_mfma_f32_16x16x32_bf16 v[104:107], v[148:151], a[204:207], v[104:107]
    ds_read_b64_tr_b16 v[220:221], v11 offset:12288
    s_add_u32 m0, s53, 57344
    v_mfma_f32_16x16x32_bf16 v[104:107], v[152:155], a[208:211], v[104:107]
    ds_read_b64_tr_b16 v[222:223], v11 offset:12800
    v_mfma_f32_16x16x32_bf16 v[104:107], v[156:159], a[212:215], v[104:107]
    buffer_load_dwordx4 v2, s[24:27], s84 offen lds
    v_mfma_f32_16x16x32_bf16 v[104:107], v[160:163], a[216:219], v[104:107]
    ds_read_b64_tr_b16 v[224:225], v10 offset:61440
    v_mfma_f32_16x16x32_bf16 v[108:111], v[164:167], a[200:203], v[108:111]
    ds_read_b64_tr_b16 v[226:227], v10 offset:61952
    v_mfma_f32_16x16x32_bf16 v[108:111], v[168:171], a[204:207], v[108:111]
    ds_read_b64_tr_b16 v[228:229], v12
    v_mfma_f32_16x16x32_bf16 v[108:111], v[172:175], a[208:211], v[108:111]
    ds_read_b64_tr_b16 v[230:231], v12 offset:512
    v_mfma_f32_16x16x32_bf16 v[108:111], v[176:179], a[212:215], v[108:111]
    ds_read_b64_tr_b16 v[232:233], v12 offset:4096
    s_add_u32 m0, s53, 61440
    v_mfma_f32_16x16x32_bf16 v[108:111], v[180:183], a[216:219], v[108:111]
    s_waitcnt lgkmcnt(15)
    s_nop 0
    ds_read_b64_tr_b16 v[234:235], v12 offset:4608
    v_mfma_f32_16x16x32_bf16 v[112:115], v[144:147], v[48:51], v[112:115]
    buffer_load_dwordx4 v2, s[24:27], s85 offen lds
    v_mfma_f32_16x16x32_bf16 v[112:115], v[148:151], v[52:55], v[112:115]
    ds_read_b64_tr_b16 v[236:237], v12 offset:8192
    v_mfma_f32_16x16x32_bf16 v[112:115], v[152:155], v[56:59], v[112:115]
    ds_read_b64_tr_b16 v[238:239], v12 offset:8704
    v_mfma_f32_16x16x32_bf16 v[112:115], v[156:159], v[60:63], v[112:115]
    ds_read_b64_tr_b16 v[240:241], v12 offset:12288
    v_mfma_f32_16x16x32_bf16 v[112:115], v[160:163], v[64:67], v[112:115]
    ds_read_b64_tr_b16 v[242:243], v12 offset:12800
    v_mfma_f32_16x16x32_bf16 v[116:119], v[164:167], v[48:51], v[116:119]
    v_mfma_f32_16x16x32_bf16 v[116:119], v[168:171], v[52:55], v[116:119]
    v_mfma_f32_16x16x32_bf16 v[116:119], v[172:175], v[56:59], v[116:119]
    v_mfma_f32_16x16x32_bf16 v[116:119], v[176:179], v[60:63], v[116:119]
    s_waitcnt vmcnt(10) lgkmcnt(0)
    s_barrier
    v_mfma_f32_16x16x32_bf16 v[116:119], v[180:183], v[64:67], v[116:119]
    v_mfma_f32_16x16x32_bf16 v[88:91], v[204:207], a[60:63], v[88:91]
    ds_read_b128 a[220:223], v8 offset:768
    s_add_u32 m0, s53, 65536
    v_mfma_f32_16x16x32_bf16 v[88:91], v[208:211], a[64:67], v[88:91]
    ds_read_b128 a[224:227], v5 offset:1024
    v_mfma_f32_16x16x32_bf16 v[88:91], v[212:215], a[68:71], v[88:91]
    buffer_load_dwordx4 v2, s[24:27], s86 offen lds
    v_mfma_f32_16x16x32_bf16 v[88:91], v[216:219], a[72:75], v[88:91]
    ds_read_b128 a[228:231], v6 offset:1024
    v_mfma_f32_16x16x32_bf16 v[88:91], v[220:223], a[76:79], v[88:91]
    ds_read_b128 a[232:235], v7 offset:1024
    v_mfma_f32_16x16x32_bf16 v[92:95], v[224:227], a[60:63], v[92:95]
    ds_read_b128 a[236:239], v8 offset:1024
    v_mfma_f32_16x16x32_bf16 v[92:95], v[228:231], a[64:67], v[92:95]
    ds_read_b128 v[68:71], v8 offset:41728
    v_mfma_f32_16x16x32_bf16 v[92:95], v[232:235], a[68:71], v[92:95]
    ds_read_b128 v[72:75], v5 offset:41984
    s_add_u32 m0, s53, 69632
    v_mfma_f32_16x16x32_bf16 v[92:95], v[236:239], a[72:75], v[92:95]
    ds_read_b128 v[76:79], v6 offset:41984
    v_mfma_f32_16x16x32_bf16 v[92:95], v[240:243], a[76:79], v[92:95]
    buffer_load_dwordx4 v2, s[24:27], s87 offen lds
    v_mfma_f32_16x16x32_bf16 v[96:99], v[204:207], a[140:143], v[96:99]
    ds_read_b128 v[80:83], v7 offset:41984
    v_mfma_f32_16x16x32_bf16 v[96:99], v[208:211], a[144:147], v[96:99]
    ds_read_b128 v[84:87], v8 offset:41984
    v_mfma_f32_16x16x32_bf16 v[96:99], v[212:215], a[148:151], v[96:99]
    ds_read_b64_tr_b16 v[144:145], v9
    v_cvt_pk_bf16_f32 v120, v88, v89
    v_mfma_f32_16x16x32_bf16 v[96:99], v[216:219], a[152:155], v[96:99]
    ds_read_b64_tr_b16 v[146:147], v9 offset:512
    v_cvt_pk_bf16_f32 v121, v90, v91
    v_mfma_f32_16x16x32_bf16 v[96:99], v[220:223], a[156:159], v[96:99]
    ds_read_b64_tr_b16 v[148:149], v9 offset:4096
    s_add_u32 m0, s53, 73728
    v_mfma_f32_16x16x32_bf16 v[100:103], v[224:227], a[140:143], v[100:103]
    ds_read_b64_tr_b16 v[150:151], v9 offset:4608
    v_mfma_f32_16x16x32_bf16 v[100:103], v[228:231], a[144:147], v[100:103]
    buffer_load_dwordx4 v2, s[24:27], s88 offen lds
    v_mfma_f32_16x16x32_bf16 v[100:103], v[232:235], a[148:151], v[100:103]
    ds_read_b64_tr_b16 v[152:153], v9 offset:8192
    v_cvt_pk_bf16_f32 v122, v92, v93
    v_mfma_f32_16x16x32_bf16 v[100:103], v[236:239], a[152:155], v[100:103]
    ds_read_b64_tr_b16 v[154:155], v9 offset:8704
    v_cvt_pk_bf16_f32 v123, v94, v95
    v_mfma_f32_16x16x32_bf16 v[100:103], v[240:243], a[156:159], v[100:103]
    s_waitcnt lgkmcnt(11)
    s_nop 0
    ds_read_b64_tr_b16 v[156:157], v9 offset:12288
    v_mfma_f32_16x16x32_bf16 v[104:107], v[204:207], a[220:223], v[104:107]
    ds_read_b64_tr_b16 v[158:159], v9 offset:12800
    v_mfma_f32_16x16x32_bf16 v[104:107], v[208:211], a[224:227], v[104:107]
    ds_read_b64_tr_b16 v[160:161], v9 offset:16384
    s_add_u32 m0, s53, 77824
    v_mfma_f32_16x16x32_bf16 v[104:107], v[212:215], a[228:231], v[104:107]
    ds_read_b64_tr_b16 v[162:163], v9 offset:16896
    v_mfma_f32_16x16x32_bf16 v[104:107], v[216:219], a[232:235], v[104:107]
    buffer_load_dwordx4 v2, s[24:27], s89 offen lds
    v_mfma_f32_16x16x32_bf16 v[104:107], v[220:223], a[236:239], v[104:107]
    ds_read_b64_tr_b16 v[164:165], v10
    v_mfma_f32_16x16x32_bf16 v[108:111], v[224:227], a[220:223], v[108:111]
    ds_read_b64_tr_b16 v[166:167], v10 offset:512
    v_mfma_f32_16x16x32_bf16 v[108:111], v[228:231], a[224:227], v[108:111]
    ds_read_b64_tr_b16 v[168:169], v10 offset:4096
    v_permlane16_swap_b32_e64 v120, v122
    v_mfma_f32_16x16x32_bf16 v[108:111], v[232:235], a[228:231], v[108:111]
    ds_read_b64_tr_b16 v[170:171], v10 offset:4608
    v_permlane16_swap_b32_e64 v121, v123
    v_mfma_f32_16x16x32_bf16 v[108:111], v[236:239], a[232:235], v[108:111]
    ds_read_b64_tr_b16 v[172:173], v10 offset:8192
    s_add_u32 m0, s53, 81920
    v_mfma_f32_16x16x32_bf16 v[108:111], v[240:243], a[236:239], v[108:111]
    s_waitcnt lgkmcnt(15)
    s_nop 0
    ds_read_b64_tr_b16 v[174:175], v10 offset:8704
    v_cvt_pk_bf16_f32 v124, v96, v97
    v_mfma_f32_16x16x32_bf16 v[112:115], v[204:207], v[68:71], v[112:115]
    buffer_load_dwordx4 v2, s[24:27], s90 offen lds
    v_mfma_f32_16x16x32_bf16 v[112:115], v[208:211], v[72:75], v[112:115]
    ds_read_b64_tr_b16 v[176:177], v10 offset:12288
    v_cvt_pk_bf16_f32 v125, v98, v99
    v_mfma_f32_16x16x32_bf16 v[112:115], v[212:215], v[76:79], v[112:115]
    ds_read_b64_tr_b16 v[178:179], v10 offset:12800
    v_cvt_pk_bf16_f32 v126, v100, v101
    v_mfma_f32_16x16x32_bf16 v[112:115], v[216:219], v[80:83], v[112:115]
    ds_read_b64_tr_b16 v[180:181], v10 offset:16384
    v_cvt_pk_bf16_f32 v127, v102, v103
    v_mfma_f32_16x16x32_bf16 v[112:115], v[220:223], v[84:87], v[112:115]
    ds_read_b64_tr_b16 v[182:183], v10 offset:16896
    v_permlane16_swap_b32_e64 v124, v126
    v_mfma_f32_16x16x32_bf16 v[116:119], v[224:227], v[68:71], v[116:119]
    global_load_dword v254, v253, s[36:37]
    v_permlane16_swap_b32_e64 v125, v127
    v_cvt_pk_bf16_f32 v128, v104, v105
    v_cvt_pk_bf16_f32 v129, v106, v107
    v_mfma_f32_16x16x32_bf16 v[116:119], v[228:231], v[72:75], v[116:119]
    s_add_u32 s24, s10, s48
    s_addc_u32 s25, s11, 0
    s_sub_u32 s26, 819200, s48
    v_mfma_f32_16x16x32_bf16 v[116:119], v[232:235], v[76:79], v[116:119]
    v_cvt_pk_bf16_f32 v130, v108, v109
    v_cvt_pk_bf16_f32 v131, v110, v111
    v_mfma_f32_16x16x32_bf16 v[116:119], v[236:239], v[80:83], v[116:119]
    s_waitcnt vmcnt(11) lgkmcnt(0)
    s_barrier
    v_mfma_f32_16x16x32_bf16 v[116:119], v[240:243], v[84:87], v[116:119]
L_loop:
    v_mfma_f32_16x16x32_bf16 v[88:91], v[144:147], a[0:3], 0
    ds_read_b64_tr_b16 v[204:205], v13 offset:20480
    s_add_u32 s54, s53, s57
    s_nop 0
    v_mfma_f32_16x16x32_bf16 v[88:91], v[148:151], a[4:7], v[88:91]
    ds_read_b64_tr_b16 v[206:207], v13 offset:20992
    s_add_u32 m0, s54, 4096
    v_mfma_f32_16x16x32_bf16 v[88:91], v[152:155], a[8:11], v[88:91]
    buffer_load_dwordx4 v2, s[24:27], 0 offen lds
    v_mfma_f32_16x16x32_bf16 v[88:91], v[156:159], a[12:15], v[88:91]
    ds_read_b64_tr_b16 v[208:209], v13 offset:24576
    v_cvt_pk_bf16_f32 v132, v112, v113
    v_mfma_f32_16x16x32_bf16 v[88:91], v[160:163], a[16:19], v[88:91]
    ds_read_b64_tr_b16 v[210:211], v13 offset:25088
    v_cvt_pk_bf16_f32 v133, v114, v115
    v_mfma_f32_16x16x32_bf16 v[92:95], v[164:167], a[0:3], 0
    ds_read_b64_tr_b16 v[212:213], v13 offset:28672
    v_cvt_pk_bf16_f32 v134, v116, v117
    v_mfma_f32_16x16x32_bf16 v[92:95], v[168:171], a[4:7], v[92:95]
    ds_read_b64_tr_b16 v[214:215], v13 offset:29184
    v_cvt_pk_bf16_f32 v135, v118, v119
    v_mfma_f32_16x16x32_bf16 v[92:95], v[172:175], a[8:11], v[92:95]
    ds_read_b64_tr_b16 v[216:217], v13 offset:32768
    s_add_u32 m0, s54, 8192
    v_mfma_f32_16x16x32_bf16 v[92:95], v[176:179], a[12:15], v[92:95]
    ds_read_b64_tr_b16 v[218:219], v13 offset:33280
    v_mfma_f32_16x16x32_bf16 v[92:95], v[180:183], a[16:19], v[92:95]
    buffer_load_dwordx4 v2, s[24:27], s72 offen lds
    v_mfma_f32_16x16x32_bf16 v[96:99], v[144:147], a[80:83], 0
    ds_read_b64_tr_b16 v[220:221], v13 offset:36864
    v_mfma_f32_16x16x32_bf16 v[96:99], v[148:151], a[84:87], v[96:99]
    ds_read_b64_tr_b16 v[222:223], v13 offset:37376
    v_mfma_f32_16x16x32_bf16 v[96:99], v[152:155], a[88:91], v[96:99]
    ds_read_b64_tr_b16 v[224:225], v14 offset:20480
    v_mfma_f32_16x16x32_bf16 v[96:99], v[156:159], a[92:95], v[96:99]
    ds_read_b64_tr_b16 v[226:227], v14 offset:20992
    v_mfma_f32_16x16x32_bf16 v[96:99], v[160:163], a[96:99], v[96:99]
    ds_read_b64_tr_b16 v[228:229], v14 offset:24576
    s_add_u32 m0, s54, 12288
    v_mfma_f32_16x16x32_bf16 v[100:103], v[164:167], a[80:83], 0
    ds_read_b64_tr_b16 v[230:231], v14 offset:25088
    v_mfma_f32_16x16x32_bf16 v[100:103], v[168:171], a[84:87], v[100:103]
    buffer_load_dwordx4 v2, s[24:27], s73 offen lds
    v_mfma_f32_16x16x32_bf16 v[100:103], v[172:175], a[88:91], v[100:103]
    ds_read_b64_tr_b16 v[232:233], v14 offset:28672
    v_mfma_f32_16x16x32_bf16 v[100:103], v[176:179], a[92:95], v[100:103]
    ds_read_b64_tr_b16 v[234:235], v14 offset:29184
    v_mfma_f32_16x16x32_bf16 v[100:103], v[180:183], a[96:99], v[100:103]
    ds_read_b64_tr_b16 v[236:237], v14 offset:32768
    v_mfma_f32_16x16x32_bf16 v[104:107], v[144:147], a[160:163], 0
    ds_read_b64_tr_b16 v[238:239], v14 offset:33280
    v_mfma_f32_16x16x32_bf16 v[104:107], v[148:151], a[164:167], v[104:107]
    ds_read_b64_tr_b16 v[240:241], v14 offset:36864
    s_add_u32 m0, s54, 16384
    v_mfma_f32_16x16x32_bf16 v[104:107], v[152:155], a[168:171], v[104:107]
    ds_read_b64_tr_b16 v[242:243], v14 offset:37376
    v_permlane16_swap_b32_e64 v128, v130
    v_mfma_f32_16x16x32_bf16 v[104:107], v[156:159], a[172:175], v[104:107]
    buffer_load_dwordx4 v2, s[24:27], s74 offen lds
    v_mfma_f32_16x16x32_bf16 v[104:107], v[160:163], a[176:179], v[104:107]
    v_permlane16_swap_b32 v129, v131
    v_permlane16_swap_b32 v132, v134
    v_mfma_f32_16x16x32_bf16 v[108:111], v[164:167], a[160:163], 0
    v_permlane16_swap_b32_e64 v133, v135
    v_mfma_f32_16x16x32_bf16 v[108:111], v[168:171], a[164:167], v[108:111]
    s_add_u32 s28, s14, s38
    s_addc_u32 s29, s15, 0
    s_sub_u32 s30, 163840, s38
    v_mfma_f32_16x16x32_bf16 v[108:111], v[172:175], a[168:171], v[108:111]
    s_add_u32 s38, s38, 128
    s_cmp_eq_u32 s38, 640
    s_cselect_b32 s38, 0, s38
    s_nop 0
    v_mfma_f32_16x16x32_bf16 v[108:111], v[176:179], a[172:175], v[108:111]
    s_add_u32 m0, s54, 20480
    v_mfma_f32_16x16x32_bf16 v[108:111], v[180:183], a[176:179], v[108:111]
    v_mfma_f32_16x16x32_bf16 v[112:115], v[144:147], a[240:243], 0
    buffer_load_dwordx4 v2, s[24:27], s75 offen lds
    v_mfma_f32_16x16x32_bf16 v[112:115], v[148:151], a[244:247], v[112:115]
    v_mfma_f32_16x16x32_bf16 v[112:115], v[152:155], a[248:251], v[112:115]
    v_mfma_f32_16x16x32_bf16 v[112:115], v[156:159], a[252:255], v[112:115]
    v_mfma_f32_16x16x32_bf16 v[112:115], v[160:163], v[24:27], v[112:115]
    v_mfma_f32_16x16x32_bf16 v[116:119], v[164:167], a[240:243], 0
    v_mfma_f32_16x16x32_bf16 v[116:119], v[168:171], a[244:247], v[116:119]
    v_mfma_f32_16x16x32_bf16 v[116:119], v[172:175], a[248:251], v[116:119]
    v_mfma_f32_16x16x32_bf16 v[116:119], v[176:179], a[252:255], v[116:119]
    s_waitcnt vmcnt(6) lgkmcnt(0)
    s_barrier
    v_mfma_f32_16x16x32_bf16 v[116:119], v[180:183], v[24:27], v[116:119]
    buffer_store_dwordx4 v[120:123], v16, s[28:31], 0 offen nt
    v_mfma_f32_16x16x32_bf16 v[88:91], v[204:207], a[20:23], v[88:91]
    v_add_u32 v13, s45, v9
    v_add_u32 v14, s45, v10
    v_mfma_f32_16x16x32_bf16 v[88:91], v[208:211], a[24:27], v[88:91]
    ds_read_b64_tr_b16 v[144:145], v13
    s_add_u32 m0, s54, 24576
    v_mfma_f32_16x16x32_bf16 v[88:91], v[212:215], a[28:31], v[88:91]
    buffer_load_dwordx4 v2, s[24:27], s76 offen lds
    v_mfma_f32_16x16x32_bf16 v[88:91], v[216:219], a[32:35], v[88:91]
    ds_read_b64_tr_b16 v[146:147], v13 offset:512
    v_mfma_f32_16x16x32_bf16 v[88:91], v[220:223], a[36:39], v[88:91]
    ds_read_b64_tr_b16 v[148:149], v13 offset:4096
    v_mfma_f32_16x16x32_bf16 v[92:95], v[224:227], a[20:23], v[92:95]
    ds_read_b64_tr_b16 v[150:151], v13 offset:4608
    v_mfma_f32_16x16x32_bf16 v[92:95], v[228:231], a[24:27], v[92:95]
    ds_read_b64_tr_b16 v[152:153], v13 offset:8192
    v_mfma_f32_16x16x32_bf16 v[92:95], v[232:235], a[28:31], v[92:95]
    ds_read_b64_tr_b16 v[154:155], v13 offset:8704
    s_add_u32 m0, s54, 28672
    v_mfma_f32_16x16x32_bf16 v[92:95], v[236:239], a[32:35], v[92:95]
    ds_read_b64_tr_b16 v[156:157], v13 offset:12288
    v_mfma_f32_16x16x32_bf16 v[92:95], v[240:243], a[36:39], v[92:95]
    buffer_load_dwordx4 v2, s[24:27], s77 offen lds
    v_mfma_f32_16x16x32_bf16 v[96:99], v[204:207], a[100:103], v[96:99]
    ds_read_b64_tr_b16 v[158:159], v13 offset:12800
    v_mfma_f32_16x16x32_bf16 v[96:99], v[208:211], a[104:107], v[96:99]
    ds_read_b64_tr_b16 v[160:161], v13 offset:16384
    v_mfma_f32_16x16x32_bf16 v[96:99], v[212:215], a[108:111], v[96:99]
    ds_read_b64_tr_b16 v[162:163], v13 offset:16896
    v_mfma_f32_16x16x32_bf16 v[96:99], v[216:219], a[112:115], v[96:99]
    ds_read_b64_tr_b16 v[164:165], v14
    v_mfma_f32_16x16x32_bf16 v[96:99], v[220:223], a[116:119], v[96:99]
    ds_read_b64_tr_b16 v[166:167], v14 offset:512
    s_add_u32 m0, s54, 32768
    v_mfma_f32_16x16x32_bf16 v[100:103], v[224:227], a[100:103], v[100:103]
    ds_read_b64_tr_b16 v[168:169], v14 offset:4096
    v_mfma_f32_16x16x32_bf16 v[100:103], v[228:231], a[104:107], v[100:103]
    buffer_load_dwordx4 v2, s[24:27], s78 offen lds
    v_mfma_f32_16x16x32_bf16 v[100:103], v[232:235], a[108:111], v[100:103]
    ds_read_b64_tr_b16 v[170:171], v14 offset:4608
    v_mfma_f32_16x16x32_bf16 v[100:103], v[236:239], a[112:115], v[100:103]
    ds_read_b64_tr_b16 v[172:173], v14 offset:8192
    v_mfma_f32_16x16x32_bf16 v[100:103], v[240:243], a[116:119], v[100:103]
    ds_read_b64_tr_b16 v[174:175], v14 offset:8704
    v_mfma_f32_16x16x32_bf16 v[104:107], v[204:207], a[180:183], v[104:107]
    ds_read_b64_tr_b16 v[176:177], v14 offset:12288
    v_mfma_f32_16x16x32_bf16 v[104:107], v[208:211], a[184:187], v[104:107]
    ds_read_b64_tr_b16 v[178:179], v14 offset:12800
    s_add_u32 m0, s54, 36864
    v_mfma_f32_16x16x32_bf16 v[104:107], v[212:215], a[188:191], v[104:107]
    ds_read_b64_tr_b16 v[180:181], v14 offset:16384
    v_mfma_f32_16x16x32_bf16 v[104:107], v[216:219], a[192:195], v[104:107]
    buffer_load_dwordx4 v2, s[24:27], s79 offen lds
    v_mfma_f32_16x16x32_bf16 v[104:107], v[220:223], a[196:199], v[104:107]
    ds_read_b64_tr_b16 v[182:183], v14 offset:16896
    v_mfma_f32_16x16x32_bf16 v[108:111], v[224:227], a[180:183], v[108:111]
    v_mfma_f32_16x16x32_bf16 v[108:111], v[228:231], a[184:187], v[108:111]
    v_mfma_f32_16x16x32_bf16 v[108:111], v[232:235], a[188:191], v[108:111]
    v_mfma_f32_16x16x32_bf16 v[108:111], v[236:239], a[192:195], v[108:111]
    s_add_u32 m0, s54, 40960
    v_mfma_f32_16x16x32_bf16 v[108:111], v[240:243], a[196:199], v[108:111]
    v_mfma_f32_16x16x32_bf16 v[112:115], v[204:207], v[28:31], v[112:115]
    buffer_load_dwordx4 v2, s[24:27], s80 offen lds
    v_mfma_f32_16x16x32_bf16 v[112:115], v[208:211], v[32:35], v[112:115]
    v_mfma_f32_16x16x32_bf16 v[112:115], v[212:215], v[36:39], v[112:115]
    v_mfma_f32_16x16x32_bf16 v[112:115], v[216:219], v[40:43], v[112:115]
    v_mfma_f32_16x16x32_bf16 v[112:115], v[220:223], v[44:47], v[112:115]
    v_mfma_f32_16x16x32_bf16 v[116:119], v[224:227], v[28:31], v[116:119]
    v_mfma_f32_16x16x32_bf16 v[116:119], v[228:231], v[32:35], v[116:119]
    v_mfma_f32_16x16x32_bf16 v[116:119], v[232:235], v[36:39], v[116:119]
    v_mfma_f32_16x16x32_bf16 v[116:119], v[236:239], v[40:43], v[116:119]
    s_waitcnt lgkmcnt(0)
    s_nop 0
    v_mfma_f32_16x16x32_bf16 v[116:119], v[240:243], v[44:47], v[116:119]
    buffer_store_dwordx4 v[124:127], v16, s[28:31], s72 offen nt
    v_mfma_f32_16x16x32_bf16 v[88:91], v[144:147], a[40:43], v[88:91]
    ds_read_b64_tr_b16 v[204:205], v13 offset:20480
    s_add_u32 s54, s53, s44
    s_nop 0
    v_mfma_f32_16x16x32_bf16 v[88:91], v[148:151], a[44:47], v[88:91]
    ds_read_b64_tr_b16 v[206:207], v13 offset:20992
    s_add_u32 m0, s54, 4096
    v_mfma_f32_16x16x32_bf16 v[88:91], v[152:155], a[48:51], v[88:91]
    buffer_load_dwordx4 v2, s[24:27], s81 offen lds
    v_mfma_f32_16x16x32_bf16 v[88:91], v[156:159], a[52:55], v[88:91]
    ds_read_b64_tr_b16 v[208:209], v13 offset:24576
    v_mfma_f32_16x16x32_bf16 v[88:91], v[160:163], a[56:59], v[88:91]
    ds_read_b64_tr_b16 v[210:211], v13 offset:25088
    v_mfma_f32_16x16x32_bf16 v[92:95], v[164:167], a[40:43], v[92:95]
    ds_read_b64_tr_b16 v[212:213], v13 offset:28672
    v_mfma_f32_16x16x32_bf16 v[92:95], v[168:171], a[44:47], v[92:95]
    ds_read_b64_tr_b16 v[214:215], v13 offset:29184
    v_mfma_f32_16x16x32_bf16 v[92:95], v[172:175], a[48:51], v[92:95]
    ds_read_b64_tr_b16 v[216:217], v13 offset:32768
    s_add_u32 m0, s54, 8192
    v_mfma_f32_16x16x32_bf16 v[92:95], v[176:179], a[52:55], v[92:95]
    ds_read_b64_tr_b16 v[218:219], v13 offset:33280
    v_mfma_f32_16x16x32_bf16 v[92:95], v[180:183], a[56:59], v[92:95]
    buffer_load_dwordx4 v2, s[24:27], s82 offen lds
    v_mfma_f32_16x16x32_bf16 v[96:99], v[144:147], a[120:123], v[96:99]
    ds_read_b64_tr_b16 v[220:221], v13 offset:36864
    v_mfma_f32_16x16x32_bf16 v[96:99], v[148:151], a[124:127], v[96:99]
    ds_read_b64_tr_b16 v[222:223], v13 offset:37376
    v_mfma_f32_16x16x32_bf16 v[96:99], v[152:155], a[128:131], v[96:99]
    ds_read_b64_tr_b16 v[224:225], v14 offset:20480
    v_mfma_f32_16x16x32_bf16 v[96:99], v[156:159], a[132:135], v[96:99]
    ds_read_b64_tr_b16 v[226:227], v14 offset:20992
    v_mfma_f32_16x16x32_bf16 v[96:99], v[160:163], a[136:139], v[96:99]
    ds_read_b64_tr_b16 v[228:229], v14 offset:24576
    s_add_u32 m0, s54, 12288
    v_mfma_f32_16x16x32_bf16 v[100:103], v[164:167], a[120:123], v[100:103]
    ds_read_b64_tr_b16 v[230:231], v14 offset:25088
    v_mfma_f32_16x16x32_bf16 v[100:103], v[168:171], a[124:127], v[100:103]
    buffer_load_dwordx4 v2, s[24:27], s83 offen lds
    v_mfma_f32_16x16x32_bf16 v[100:103], v[172:175], a[128:131], v[100:103]
    ds_read_b64_tr_b16 v[232:233], v14 offset:28672
    v_mfma_f32_16x16x32_bf16 v[100:103], v[176:179], a[132:135], v[100:103]
    ds_read_b64_tr_b16 v[234:235], v14 offset:29184
    v_mfma_f32_16x16x32_bf16 v[100:103], v[180:183], a[136:139], v[100:103]
    ds_read_b64_tr_b16 v[236:237], v14 offset:32768
    v_mfma_f32_16x16x32_bf16 v[104:107], v[144:147], a[200:203], v[104:107]
    ds_read_b64_tr_b16 v[238:239], v14 offset:33280
    v_mfma_f32_16x16x32_bf16 v[104:107], v[148:151], a[204:207], v[104:107]
    ds_read_b64_tr_b16 v[240:241], v14 offset:36864
    s_add_u32 m0, s54, 16384
    v_mfma_f32_16x16x32_bf16 v[104:107], v[152:155], a[208:211], v[104:107]
    ds_read_b64_tr_b16 v[242:243], v14 offset:37376
    v_mfma_f32_16x16x32_bf16 v[104:107], v[156:159], a[212:215], v[104:107]
    buffer_load_dwordx4 v2, s[24:27], s84 offen lds
    v_mfma_f32_16x16x32_bf16 v[104:107], v[160:163], a[216:219], v[104:107]
    v_mfma_f32_16x16x32_bf16 v[108:111], v[164:167], a[200:203], v[108:111]
    v_mfma_f32_16x16x32_bf16 v[108:111], v[168:171], a[204:207], v[108:111]
    v_mfma_f32_16x16x32_bf16 v[108:111], v[172:175], a[208:211], v[108:111]
    v_mfma_f32_16x16x32_bf16 v[108:111], v[176:179], a[212:215], v[108:111]
    s_add_u32 m0, s54, 20480
    v_mfma_f32_16x16x32_bf16 v[108:111], v[180:183], a[216:219], v[108:111]
    v_mfma_f32_16x16x32_bf16 v[112:115], v[144:147], v[48:51], v[112:115]
    buffer_load_dwordx4 v2, s[24:27], s85 offen lds
    v_mfma_f32_16x16x32_bf16 v[112:115], v[148:151], v[52:55], v[112:115]
    v_mfma_f32_16x16x32_bf16 v[112:115], v[152:155], v[56:59], v[112:115]
    v_mfma_f32_16x16x32_bf16 v[112:115], v[156:159], v[60:63], v[112:115]
    v_mfma_f32_16x16x32_bf16 v[112:115], v[160:163], v[64:67], v[112:115]
    v_mfma_f32_16x16x32_bf16 v[116:119], v[164:167], v[48:51], v[116:119]
    v_mfma_f32_16x16x32_bf16 v[116:119], v[168:171], v[52:55], v[116:119]
    v_mfma_f32_16x16x32_bf16 v[116:119], v[172:175], v[56:59], v[116:119]
    v_mfma_f32_16x16x32_bf16 v[116:119], v[176:179], v[60:63], v[116:119]
    s_waitcnt vmcnt(6) lgkmcnt(0)
    s_barrier
    v_mfma_f32_16x16x32_bf16 v[116:119], v[180:183], v[64:67], v[116:119]
    buffer_store_dwordx4 v[128:131], v16, s[28:31], s73 offen nt
    v_mfma_f32_16x16x32_bf16 v[88:91], v[204:207], a[60:63], v[88:91]
    v_add_u32 v13, s57, v9
    v_add_u32 v14, s57, v10
    v_mfma_f32_16x16x32_bf16 v[88:91], v[208:211], a[64:67], v[88:91]
    ds_read_b64_tr_b16 v[144:145], v13
    s_add_u32 m0, s54, 24576
    v_mfma_f32_16x16x32_bf16 v[88:91], v[212:215], a[68:71], v[88:91]
    buffer_load_dwordx4 v2, s[24:27], s86 offen lds
    v_mfma_f32_16x16x32_bf16 v[88:91], v[216:219], a[72:75], v[88:91]
    ds_read_b64_tr_b16 v[146:147], v13 offset:512
    v_mfma_f32_16x16x32_bf16 v[88:91], v[220:223], a[76:79], v[88:91]
    ds_read_b64_tr_b16 v[148:149], v13 offset:4096
    v_mfma_f32_16x16x32_bf16 v[92:95], v[224:227], a[60:63], v[92:95]
    ds_read_b64_tr_b16 v[150:151], v13 offset:4608
    v_mfma_f32_16x16x32_bf16 v[92:95], v[228:231], a[64:67], v[92:95]
    ds_read_b64_tr_b16 v[152:153], v13 offset:8192
    v_mfma_f32_16x16x32_bf16 v[92:95], v[232:235], a[68:71], v[92:95]
    ds_read_b64_tr_b16 v[154:155], v13 offset:8704
    s_add_u32 m0, s54, 28672
    v_mfma_f32_16x16x32_bf16 v[92:95], v[236:239], a[72:75], v[92:95]
    ds_read_b64_tr_b16 v[156:157], v13 offset:12288
    v_mfma_f32_16x16x32_bf16 v[92:95], v[240:243], a[76:79], v[92:95]
    buffer_load_dwordx4 v2, s[24:27], s87 offen lds
    v_mfma_f32_16x16x32_bf16 v[96:99], v[204:207], a[140:143], v[96:99]
    ds_read_b64_tr_b16 v[158:159], v13 offset:12800
    v_mfma_f32_16x16x32_bf16 v[96:99], v[208:211], a[144:147], v[96:99]
    ds_read_b64_tr_b16 v[160:161], v13 offset:16384
    v_mfma_f32_16x16x32_bf16 v[96:99], v[212:215], a[148:151], v[96:99]
    ds_read_b64_tr_b16 v[162:163], v13 offset:16896
    v_cvt_pk_bf16_f32 v120, v88, v89
    v_mfma_f32_16x16x32_bf16 v[96:99], v[216:219], a[152:155], v[96:99]
    ds_read_b64_tr_b16 v[164:165], v14
    v_cvt_pk_bf16_f32 v121, v90, v91
    v_mfma_f32_16x16x32_bf16 v[96:99], v[220:223], a[156:159], v[96:99]
    ds_read_b64_tr_b16 v[166:167], v14 offset:512
    s_add_u32 m0, s54, 32768
    v_mfma_f32_16x16x32_bf16 v[100:103], v[224:227], a[140:143], v[100:103]
    ds_read_b64_tr_b16 v[168:169], v14 offset:4096
    v_mfma_f32_16x16x32_bf16 v[100:103], v[228:231], a[144:147], v[100:103]
    buffer_load_dwordx4 v2, s[24:27], s88 offen lds
    v_mfma_f32_16x16x32_bf16 v[100:103], v[232:235], a[148:151], v[100:103]
    ds_read_b64_tr_b16 v[170:171], v14 offset:4608
    v_cvt_pk_bf16_f32 v122, v92, v93
    v_mfma_f32_16x16x32_bf16 v[100:103], v[236:239], a[152:155], v[100:103]
    ds_read_b64_tr_b16 v[172:173], v14 offset:8192
    v_cvt_pk_bf16_f32 v123, v94, v95
    v_mfma_f32_16x16x32_bf16 v[100:103], v[240:243], a[156:159], v[100:103]
    ds_read_b64_tr_b16 v[174:175], v14 offset:8704
    v_mfma_f32_16x16x32_bf16 v[104:107], v[204:207], a[220:223], v[104:107]
    ds_read_b64_tr_b16 v[176:177], v14 offset:12288
    v_mfma_f32_16x16x32_bf16 v[104:107], v[208:211], a[224:227], v[104:107]
    ds_read_b64_tr_b16 v[178:179], v14 offset:12800
    s_add_u32 m0, s54, 36864
    v_mfma_f32_16x16x32_bf16 v[104:107], v[212:215], a[228:231], v[104:107]
    ds_read_b64_tr_b16 v[180:181], v14 offset:16384
    v_mfma_f32_16x16x32_bf16 v[104:107], v[216:219], a[232:235], v[104:107]
    buffer_load_dwordx4 v2, s[24:27], s89 offen lds
    v_mfma_f32_16x16x32_bf16 v[104:107], v[220:223], a[236:239], v[104:107]
    ds_read_b64_tr_b16 v[182:183], v14 offset:16896
    v_mfma_f32_16x16x32_bf16 v[108:111], v[224:227], a[220:223], v[108:111]
    s_mov_b32 s58, s57
    s_mov_b32 s57, s45
    v_mfma_f32_16x16x32_bf16 v[108:111], v[228:231], a[224:227], v[108:111]
    s_mov_b32 s45, s44
    s_mov_b32 s44, s58
    v_permlane16_swap_b32_e64 v120, v122
    v_mfma_f32_16x16x32_bf16 v[108:111], v[232:235], a[228:231], v[108:111]
    v_permlane16_swap_b32_e64 v121, v123
    v_cvt_pk_bf16_f32 v124, v96, v97
    v_mfma_f32_16x16x32_bf16 v[108:111], v[236:239], a[232:235], v[108:111]
    s_add_u32 m0, s54, 40960
    v_cvt_pk_bf16_f32 v125, v98, v99
    v_mfma_f32_16x16x32_bf16 v[108:111], v[240:243], a[236:239], v[108:111]
    v_cvt_pk_bf16_f32 v126, v100, v101
    v_cvt_pk_bf16_f32 v127, v102, v103
    v_mfma_f32_16x16x32_bf16 v[112:115], v[204:207], v[68:71], v[112:115]
    buffer_load_dwordx4 v2, s[24:27], s90 offen lds
    v_mfma_f32_16x16x32_bf16 v[112:115], v[208:211], v[72:75], v[112:115]
    v_permlane16_swap_b32 v124, v126
    v_permlane16_swap_b32 v125, v127
    v_mfma_f32_16x16x32_bf16 v[112:115], v[212:215], v[76:79], v[112:115]
    v_cvt_pk_bf16_f32 v128, v104, v105
    v_cvt_pk_bf16_f32 v129, v106, v107
    v_mfma_f32_16x16x32_bf16 v[112:115], v[216:219], v[80:83], v[112:115]
    s_add_u32 s24, s10, s3
    s_addc_u32 s25, s11, 0
    s_sub_u32 s26, 819200, s3
    v_mfma_f32_16x16x32_bf16 v[112:115], v[220:223], v[84:87], v[112:115]
    s_add_u32 s3, s3, 128
    s_cmp_eq_u32 s3, 640
    s_cselect_b32 s3, 0, s3
    s_nop 0
    v_mfma_f32_16x16x32_bf16 v[116:119], v[224:227], v[68:71], v[116:119]
    v_mfma_f32_16x16x32_bf16 v[116:119], v[228:231], v[72:75], v[116:119]
    v_mfma_f32_16x16x32_bf16 v[116:119], v[232:235], v[76:79], v[116:119]
    v_cvt_pk_bf16_f32 v130, v108, v109
    v_cvt_pk_bf16_f32 v131, v110, v111
    v_mfma_f32_16x16x32_bf16 v[116:119], v[236:239], v[80:83], v[116:119]
    s_waitcnt lgkmcnt(0)
    v_mfma_f32_16x16x32_bf16 v[116:119], v[240:243], v[84:87], v[116:119]
    buffer_store_dwordx4 v[132:135], v16, s[28:31], s74 offen nt
    s_add_u32 s55, s55, 1
    s_cmp_lt_u32 s55, 3
    s_cbranch_scc1 L_loop
    v_mfma_f32_16x16x32_bf16 v[88:91], v[144:147], a[0:3], 0
    ds_read_b64_tr_b16 v[204:205], v9 offset:20480
    v_cvt_pk_bf16_f32 v132, v112, v113
    v_mfma_f32_16x16x32_bf16 v[88:91], v[148:151], a[4:7], v[88:91]
    ds_read_b64_tr_b16 v[206:207], v9 offset:20992
    v_cvt_pk_bf16_f32 v133, v114, v115
    v_mfma_f32_16x16x32_bf16 v[88:91], v[152:155], a[8:11], v[88:91]
    ds_read_b64_tr_b16 v[208:209], v9 offset:24576
    v_mfma_f32_16x16x32_bf16 v[88:91], v[156:159], a[12:15], v[88:91]
    ds_read_b64_tr_b16 v[210:211], v9 offset:25088
    v_mfma_f32_16x16x32_bf16 v[88:91], v[160:163], a[16:19], v[88:91]
    ds_read_b64_tr_b16 v[212:213], v9 offset:28672
    v_cvt_pk_bf16_f32 v134, v116, v117
    v_mfma_f32_16x16x32_bf16 v[92:95], v[164:167], a[0:3], 0
    ds_read_b64_tr_b16 v[214:215], v9 offset:29184
    v_cvt_pk_bf16_f32 v135, v118, v119
    v_mfma_f32_16x16x32_bf16 v[92:95], v[168:171], a[4:7], v[92:95]
    ds_read_b64_tr_b16 v[216:217], v9 offset:32768
    v_mfma_f32_16x16x32_bf16 v[92:95], v[172:175], a[8:11], v[92:95]
    ds_read_b64_tr_b16 v[218:219], v9 offset:33280
    v_mfma_f32_16x16x32_bf16 v[92:95], v[176:179], a[12:15], v[92:95]
    ds_read_b64_tr_b16 v[220:221], v9 offset:36864
    v_mfma_f32_16x16x32_bf16 v[92:95], v[180:183], a[16:19], v[92:95]
    ds_read_b64_tr_b16 v[222:223], v9 offset:37376
    v_mfma_f32_16x16x32_bf16 v[96:99], v[144:147], a[80:83], 0
    ds_read_b64_tr_b16 v[224:225], v10 offset:20480
    v_mfma_f32_16x16x32_bf16 v[96:99], v[148:151], a[84:87], v[96:99]
    ds_read_b64_tr_b16 v[226:227], v10 offset:20992
    v_mfma_f32_16x16x32_bf16 v[96:99], v[152:155], a[88:91], v[96:99]
    ds_read_b64_tr_b16 v[228:229], v10 offset:24576
    v_mfma_f32_16x16x32_bf16 v[96:99], v[156:159], a[92:95], v[96:99]
    ds_read_b64_tr_b16 v[230:231], v10 offset:25088
    v_mfma_f32_16x16x32_bf16 v[96:99], v[160:163], a[96:99], v[96:99]
    ds_read_b64_tr_b16 v[232:233], v10 offset:28672
    v_mfma_f32_16x16x32_bf16 v[100:103], v[164:167], a[80:83], 0
    ds_read_b64_tr_b16 v[234:235], v10 offset:29184
    v_mfma_f32_16x16x32_bf16 v[100:103], v[168:171], a[84:87], v[100:103]
    ds_read_b64_tr_b16 v[236:237], v10 offset:32768
    v_mfma_f32_16x16x32_bf16 v[100:103], v[172:175], a[88:91], v[100:103]
    ds_read_b64_tr_b16 v[238:239], v10 offset:33280
    v_mfma_f32_16x16x32_bf16 v[100:103], v[176:179], a[92:95], v[100:103]
    ds_read_b64_tr_b16 v[240:241], v10 offset:36864
    v_mfma_f32_16x16x32_bf16 v[100:103], v[180:183], a[96:99], v[100:103]
    ds_read_b64_tr_b16 v[242:243], v10 offset:37376
    v_mfma_f32_16x16x32_bf16 v[104:107], v[144:147], a[160:163], 0
    v_mfma_f32_16x16x32_bf16 v[104:107], v[148:151], a[164:167], v[104:107]
    v_mfma_f32_16x16x32_bf16 v[104:107], v[152:155], a[168:171], v[104:107]
    v_permlane16_swap_b32 v128, v130
    v_permlane16_swap_b32 v129, v131
    v_mfma_f32_16x16x32_bf16 v[104:107], v[156:159], a[172:175], v[104:107]
    v_mfma_f32_16x16x32_bf16 v[104:107], v[160:163], a[176:179], v[104:107]
    v_permlane16_swap_b32 v132, v134
    v_permlane16_swap_b32 v133, v135
    v_mfma_f32_16x16x32_bf16 v[108:111], v[164:167], a[160:163], 0
    v_mfma_f32_16x16x32_bf16 v[108:111], v[168:171], a[164:167], v[108:111]
    s_add_u32 s28, s14, s51
    s_addc_u32 s29, s15, 0
    s_sub_u32 s30, 163840, s51
    v_mfma_f32_16x16x32_bf16 v[108:111], v[172:175], a[168:171], v[108:111]
    v_mfma_f32_16x16x32_bf16 v[108:111], v[176:179], a[172:175], v[108:111]
    v_mfma_f32_16x16x32_bf16 v[108:111], v[180:183], a[176:179], v[108:111]
    v_mfma_f32_16x16x32_bf16 v[112:115], v[144:147], a[240:243], 0
    v_mfma_f32_16x16x32_bf16 v[112:115], v[148:151], a[244:247], v[112:115]
    v_mfma_f32_16x16x32_bf16 v[112:115], v[152:155], a[248:251], v[112:115]
    v_mfma_f32_16x16x32_bf16 v[112:115], v[156:159], a[252:255], v[112:115]
    v_mfma_f32_16x16x32_bf16 v[112:115], v[160:163], v[24:27], v[112:115]
    v_mfma_f32_16x16x32_bf16 v[116:119], v[164:167], a[240:243], 0
    v_mfma_f32_16x16x32_bf16 v[116:119], v[168:171], a[244:247], v[116:119]
    v_mfma_f32_16x16x32_bf16 v[116:119], v[172:175], a[248:251], v[116:119]
    v_mfma_f32_16x16x32_bf16 v[116:119], v[176:179], a[252:255], v[116:119]
    s_waitcnt vmcnt(1) lgkmcnt(0)
    s_barrier
    v_mfma_f32_16x16x32_bf16 v[116:119], v[180:183], v[24:27], v[116:119]
    buffer_store_dwordx4 v[120:123], v16, s[28:31], 0 offen nt
    v_mfma_f32_16x16x32_bf16 v[88:91], v[204:207], a[20:23], v[88:91]
    ds_read_b64_tr_b16 v[144:145], v9 offset:40960
    v_mfma_f32_16x16x32_bf16 v[88:91], v[208:211], a[24:27], v[88:91]
    ds_read_b64_tr_b16 v[146:147], v9 offset:41472
    v_mfma_f32_16x16x32_bf16 v[88:91], v[212:215], a[28:31], v[88:91]
    ds_read_b64_tr_b16 v[148:149], v9 offset:45056
    v_mfma_f32_16x16x32_bf16 v[88:91], v[216:219], a[32:35], v[88:91]
    ds_read_b64_tr_b16 v[150:151], v9 offset:45568
    v_mfma_f32_16x16x32_bf16 v[88:91], v[220:223], a[36:39], v[88:91]
    ds_read_b64_tr_b16 v[152:153], v9 offset:49152
    v_mfma_f32_16x16x32_bf16 v[92:95], v[224:227], a[20:23], v[92:95]
    ds_read_b64_tr_b16 v[154:155], v9 offset:49664
    v_mfma_f32_16x16x32_bf16 v[92:95], v[228:231], a[24:27], v[92:95]
    ds_read_b64_tr_b16 v[156:157], v9 offset:53248
    v_mfma_f32_16x16x32_bf16 v[92:95], v[232:235], a[28:31], v[92:95]
    ds_read_b64_tr_b16 v[158:159], v9 offset:53760
    v_mfma_f32_16x16x32_bf16 v[92:95], v[236:239], a[32:35], v[92:95]
    ds_read_b64_tr_b16 v[160:161], v9 offset:57344
    v_mfma_f32_16x16x32_bf16 v[92:95], v[240:243], a[36:39], v[92:95]
    ds_read_b64_tr_b16 v[162:163], v9 offset:57856
    v_mfma_f32_16x16x32_bf16 v[96:99], v[204:207], a[100:103], v[96:99]
    ds_read_b64_tr_b16 v[164:165], v10 offset:40960
    v_mfma_f32_16x16x32_bf16 v[96:99], v[208:211], a[104:107], v[96:99]
    ds_read_b64_tr_b16 v[166:167], v10 offset:41472
    v_mfma_f32_16x16x32_bf16 v[96:99], v[212:215], a[108:111], v[96:99]
    ds_read_b64_tr_b16 v[168:169], v10 offset:45056
    v_mfma_f32_16x16x32_bf16 v[96:99], v[216:219], a[112:115], v[96:99]
    ds_read_b64_tr_b16 v[170:171], v10 offset:45568
    v_mfma_f32_16x16x32_bf16 v[96:99], v[220:223], a[116:119], v[96:99]
    ds_read_b64_tr_b16 v[172:173], v10 offset:49152
    v_mfma_f32_16x16x32_bf16 v[100:103], v[224:227], a[100:103], v[100:103]
    ds_read_b64_tr_b16 v[174:175], v10 offset:49664
    v_mfma_f32_16x16x32_bf16 v[100:103], v[228:231], a[104:107], v[100:103]
    ds_read_b64_tr_b16 v[176:177], v10 offset:53248
    v_mfma_f32_16x16x32_bf16 v[100:103], v[232:235], a[108:111], v[100:103]
    ds_read_b64_tr_b16 v[178:179], v10 offset:53760
    v_mfma_f32_16x16x32_bf16 v[100:103], v[236:239], a[112:115], v[100:103]
    ds_read_b64_tr_b16 v[180:181], v10 offset:57344
    v_mfma_f32_16x16x32_bf16 v[100:103], v[240:243], a[116:119], v[100:103]
    ds_read_b64_tr_b16 v[182:183], v10 offset:57856
    v_mfma_f32_16x16x32_bf16 v[104:107], v[204:207], a[180:183], v[104:107]
    v_mfma_f32_16x16x32_bf16 v[104:107], v[208:211], a[184:187], v[104:107]
    v_mfma_f32_16x16x32_bf16 v[104:107], v[212:215], a[188:191], v[104:107]
    v_mfma_f32_16x16x32_bf16 v[104:107], v[216:219], a[192:195], v[104:107]
    v_mfma_f32_16x16x32_bf16 v[104:107], v[220:223], a[196:199], v[104:107]
    v_mfma_f32_16x16x32_bf16 v[108:111], v[224:227], a[180:183], v[108:111]
    v_mfma_f32_16x16x32_bf16 v[108:111], v[228:231], a[184:187], v[108:111]
    v_mfma_f32_16x16x32_bf16 v[108:111], v[232:235], a[188:191], v[108:111]
    v_mfma_f32_16x16x32_bf16 v[108:111], v[236:239], a[192:195], v[108:111]
    v_mfma_f32_16x16x32_bf16 v[108:111], v[240:243], a[196:199], v[108:111]
    v_mfma_f32_16x16x32_bf16 v[112:115], v[204:207], v[28:31], v[112:115]
    v_mfma_f32_16x16x32_bf16 v[112:115], v[208:211], v[32:35], v[112:115]
    v_mfma_f32_16x16x32_bf16 v[112:115], v[212:215], v[36:39], v[112:115]
    v_mfma_f32_16x16x32_bf16 v[112:115], v[216:219], v[40:43], v[112:115]
    v_mfma_f32_16x16x32_bf16 v[112:115], v[220:223], v[44:47], v[112:115]
    v_mfma_f32_16x16x32_bf16 v[116:119], v[224:227], v[28:31], v[116:119]
    v_mfma_f32_16x16x32_bf16 v[116:119], v[228:231], v[32:35], v[116:119]
    v_mfma_f32_16x16x32_bf16 v[116:119], v[232:235], v[36:39], v[116:119]
    v_mfma_f32_16x16x32_bf16 v[116:119], v[236:239], v[40:43], v[116:119]
    s_waitcnt lgkmcnt(0)
    s_nop 0
    v_mfma_f32_16x16x32_bf16 v[116:119], v[240:243], v[44:47], v[116:119]
    buffer_store_dwordx4 v[124:127], v16, s[28:31], s72 offen nt
    v_mfma_f32_16x16x32_bf16 v[88:91], v[144:147], a[40:43], v[88:91]
    ds_read_b64_tr_b16 v[204:205], v9 offset:61440
    v_mfma_f32_16x16x32_bf16 v[88:91], v[148:151], a[44:47], v[88:91]
    ds_read_b64_tr_b16 v[206:207], v9 offset:61952
    v_mfma_f32_16x16x32_bf16 v[88:91], v[152:155], a[48:51], v[88:91]
    ds_read_b64_tr_b16 v[208:209], v11
    v_mfma_f32_16x16x32_bf16 v[88:91], v[156:159], a[52:55], v[88:91]
    ds_read_b64_tr_b16 v[210:211], v11 offset:512
    v_mfma_f32_16x16x32_bf16 v[88:91], v[160:163], a[56:59], v[88:91]
    ds_read_b64_tr_b16 v[212:213], v11 offset:4096
    v_mfma_f32_16x16x32_bf16 v[92:95], v[164:167], a[40:43], v[92:95]
    ds_read_b64_tr_b16 v[214:215], v11 offset:4608
    v_mfma_f32_16x16x32_bf16 v[92:95], v[168:171], a[44:47], v[92:95]
    ds_read_b64_tr_b16 v[216:217], v11 offset:8192
    v_mfma_f32_16x16x32_bf16 v[92:95], v[172:175], a[48:51], v[92:95]
    ds_read_b64_tr_b16 v[218:219], v11 offset:8704
    v_mfma_f32_16x16x32_bf16 v[92:95], v[176:179], a[52:55], v[92:95]
    ds_read_b64_tr_b16 v[220:221], v11 offset:12288
    v_mfma_f32_16x16x32_bf16 v[92:95], v[180:183], a[56:59], v[92:95]
    ds_read_b64_tr_b16 v[222:223], v11 offset:12800
    v_mfma_f32_16x16x32_bf16 v[96:99], v[144:147], a[120:123], v[96:99]
    ds_read_b64_tr_b16 v[224:225], v10 offset:61440
    v_mfma_f32_16x16x32_bf16 v[96:99], v[148:151], a[124:127], v[96:99]
    ds_read_b64_tr_b16 v[226:227], v10 offset:61952
    v_mfma_f32_16x16x32_bf16 v[96:99], v[152:155], a[128:131], v[96:99]
    ds_read_b64_tr_b16 v[228:229], v12
    v_mfma_f32_16x16x32_bf16 v[96:99], v[156:159], a[132:135], v[96:99]
    ds_read_b64_tr_b16 v[230:231], v12 offset:512
    v_mfma_f32_16x16x32_bf16 v[96:99], v[160:163], a[136:139], v[96:99]
    ds_read_b64_tr_b16 v[232:233], v12 offset:4096
    v_mfma_f32_16x16x32_bf16 v[100:103], v[164:167], a[120:123], v[100:103]
    ds_read_b64_tr_b16 v[234:235], v12 offset:4608
    v_mfma_f32_16x16x32_bf16 v[100:103], v[168:171], a[124:127], v[100:103]
    ds_read_b64_tr_b16 v[236:237], v12 offset:8192
    v_mfma_f32_16x16x32_bf16 v[100:103], v[172:175], a[128:131], v[100:103]
    ds_read_b64_tr_b16 v[238:239], v12 offset:8704
    v_mfma_f32_16x16x32_bf16 v[100:103], v[176:179], a[132:135], v[100:103]
    ds_read_b64_tr_b16 v[240:241], v12 offset:12288
    v_mfma_f32_16x16x32_bf16 v[100:103], v[180:183], a[136:139], v[100:103]
    ds_read_b64_tr_b16 v[242:243], v12 offset:12800
    v_mfma_f32_16x16x32_bf16 v[104:107], v[144:147], a[200:203], v[104:107]
    v_mfma_f32_16x16x32_bf16 v[104:107], v[148:151], a[204:207], v[104:107]
    v_mfma_f32_16x16x32_bf16 v[104:107], v[152:155], a[208:211], v[104:107]
    v_mfma_f32_16x16x32_bf16 v[104:107], v[156:159], a[212:215], v[104:107]
    v_mfma_f32_16x16x32_bf16 v[104:107], v[160:163], a[216:219], v[104:107]
    v_mfma_f32_16x16x32_bf16 v[108:111], v[164:167], a[200:203], v[108:111]
    v_mfma_f32_16x16x32_bf16 v[108:111], v[168:171], a[204:207], v[108:111]
    v_mfma_f32_16x16x32_bf16 v[108:111], v[172:175], a[208:211], v[108:111]
    v_mfma_f32_16x16x32_bf16 v[108:111], v[176:179], a[212:215], v[108:111]
    v_mfma_f32_16x16x32_bf16 v[108:111], v[180:183], a[216:219], v[108:111]
    buffer_store_dwordx4 v[128:131], v16, s[28:31], s73 offen nt
    v_mfma_f32_16x16x32_bf16 v[112:115], v[144:147], v[48:51], v[112:115]
    v_mfma_f32_16x16x32_bf16 v[112:115], v[148:151], v[52:55], v[112:115]
    v_mfma_f32_16x16x32_bf16 v[112:115], v[152:155], v[56:59], v[112:115]
    v_mfma_f32_16x16x32_bf16 v[112:115], v[156:159], v[60:63], v[112:115]
    v_mfma_f32_16x16x32_bf16 v[112:115], v[160:163], v[64:67], v[112:115]
    v_mfma_f32_16x16x32_bf16 v[116:119], v[164:167], v[48:51], v[116:119]
    v_mfma_f32_16x16x32_bf16 v[116:119], v[168:171], v[52:55], v[116:119]
    v_mfma_f32_16x16x32_bf16 v[116:119], v[172:175], v[56:59], v[116:119]
    v_mfma_f32_16x16x32_bf16 v[116:119], v[176:179], v[60:63], v[116:119]
    s_waitcnt lgkmcnt(0)
    s_nop 0
    v_mfma_f32_16x16x32_bf16 v[116:119], v[180:183], v[64:67], v[116:119]
    buffer_store_dwordx4 v[132:135], v16, s[28:31], s74 offen nt
    v_mfma_f32_16x16x32_bf16 v[88:91], v[204:207], a[60:63], v[88:91]
    s_add_u32 s28, s14, s52
    s_addc_u32 s29, s15, 0
    s_sub_u32 s30, 163840, s52
    v_mfma_f32_16x16x32_bf16 v[88:91], v[208:211], a[64:67], v[88:91]
    v_mfma_f32_16x16x32_bf16 v[88:91], v[212:215], a[68:71], v[88:91]
    v_mfma_f32_16x16x32_bf16 v[88:91], v[216:219], a[72:75], v[88:91]
    v_mfma_f32_16x16x32_bf16 v[88:91], v[220:223], a[76:79], v[88:91]
    v_mfma_f32_16x16x32_bf16 v[92:95], v[224:227], a[60:63], v[92:95]
    v_mfma_f32_16x16x32_bf16 v[92:95], v[228:231], a[64:67], v[92:95]
    v_mfma_f32_16x16x32_bf16 v[92:95], v[232:235], a[68:71], v[92:95]
    v_mfma_f32_16x16x32_bf16 v[92:95], v[236:239], a[72:75], v[92:95]
    v_mfma_f32_16x16x32_bf16 v[92:95], v[240:243], a[76:79], v[92:95]
    v_mfma_f32_16x16x32_bf16 v[96:99], v[204:207], a[140:143], v[96:99]
    v_mfma_f32_16x16x32_bf16 v[96:99], v[208:211], a[144:147], v[96:99]
    s_nop 0
    s_nop 0
    v_cvt_pk_bf16_f32 v120, v88, v89
    v_cvt_pk_bf16_f32 v121, v90, v91
    v_mfma_f32_16x16x32_bf16 v[96:99], v[212:215], a[148:151], v[96:99]
    v_mfma_f32_16x16x32_bf16 v[96:99], v[216:219], a[152:155], v[96:99]
    ds_write_b64 v246, v[120:121]
    v_mfma_f32_16x16x32_bf16 v[96:99], v[220:223], a[156:159], v[96:99]
    v_mfma_f32_16x16x32_bf16 v[100:103], v[224:227], a[140:143], v[100:103]
    v_mfma_f32_16x16x32_bf16 v[100:103], v[228:231], a[144:147], v[100:103]
    v_cvt_pk_bf16_f32 v122, v92, v93
    v_cvt_pk_bf16_f32 v123, v94, v95
    v_mfma_f32_16x16x32_bf16 v[100:103], v[232:235], a[148:151], v[100:103]
    v_mfma_f32_16x16x32_bf16 v[100:103], v[236:239], a[152:155], v[100:103]
    ds_write_b64 v247, v[122:123]
    v_mfma_f32_16x16x32_bf16 v[100:103], v[240:243], a[156:159], v[100:103]
    ds_read_b128 v[184:187], v248
    v_mfma_f32_16x16x32_bf16 v[104:107], v[204:207], a[220:223], v[104:107]
    v_mfma_f32_16x16x32_bf16 v[104:107], v[208:211], a[224:227], v[104:107]
    v_cvt_pk_bf16_f32 v124, v96, v97
    v_cvt_pk_bf16_f32 v125, v98, v99
    v_mfma_f32_16x16x32_bf16 v[104:107], v[212:215], a[228:231], v[104:107]
    v_mfma_f32_16x16x32_bf16 v[104:107], v[216:219], a[232:235], v[104:107]
    ds_write_b64 v246, v[124:125] offset:1024
    v_mfma_f32_16x16x32_bf16 v[104:107], v[220:223], a[236:239], v[104:107]
    v_mfma_f32_16x16x32_bf16 v[108:111], v[224:227], a[220:223], v[108:111]
    s_waitcnt lgkmcnt(1)
    s_nop 0
    buffer_store_dwordx4 v[184:187], v249, s[28:31], 0 offen nt
    v_mfma_f32_16x16x32_bf16 v[108:111], v[228:231], a[224:227], v[108:111]
    v_cvt_pk_bf16_f32 v126, v100, v101
    v_cvt_pk_bf16_f32 v127, v102, v103
    v_mfma_f32_16x16x32_bf16 v[108:111], v[232:235], a[228:231], v[108:111]
    v_mfma_f32_16x16x32_bf16 v[108:111], v[236:239], a[232:235], v[108:111]
    ds_write_b64 v247, v[126:127] offset:1024
    v_mfma_f32_16x16x32_bf16 v[108:111], v[240:243], a[236:239], v[108:111]
    ds_read_b128 v[188:191], v248 offset:1024
    v_mfma_f32_16x16x32_bf16 v[112:115], v[204:207], v[68:71], v[112:115]
    v_mfma_f32_16x16x32_bf16 v[112:115], v[208:211], v[72:75], v[112:115]
    v_cvt_pk_bf16_f32 v128, v104, v105
    v_cvt_pk_bf16_f32 v129, v106, v107
    v_mfma_f32_16x16x32_bf16 v[112:115], v[212:215], v[76:79], v[112:115]
    v_mfma_f32_16x16x32_bf16 v[112:115], v[216:219], v[80:83], v[112:115]
    ds_write_b64 v246, v[128:129] offset:2048
    v_mfma_f32_16x16x32_bf16 v[112:115], v[220:223], v[84:87], v[112:115]
    v_mfma_f32_16x16x32_bf16 v[116:119], v[224:227], v[68:71], v[116:119]
    s_waitcnt lgkmcnt(1)
    s_nop 0
    buffer_store_dwordx4 v[188:191], v249, s[28:31], s72 offen nt
    v_mfma_f32_16x16x32_bf16 v[116:119], v[228:231], v[72:75], v[116:119]
    v_cvt_pk_bf16_f32 v130, v108, v109
    v_cvt_pk_bf16_f32 v131, v110, v111
    v_mfma_f32_16x16x32_bf16 v[116:119], v[232:235], v[76:79], v[116:119]
    v_mfma_f32_16x16x32_bf16 v[116:119], v[236:239], v[80:83], v[116:119]
    ds_write_b64 v247, v[130:131] offset:2048
    v_mfma_f32_16x16x32_bf16 v[116:119], v[240:243], v[84:87], v[116:119]
    ds_read_b128 v[192:195], v248 offset:2048
    v_cvt_pk_bf16_f32 v132, v112, v113
    v_cvt_pk_bf16_f32 v133, v114, v115
    ds_write_b64 v246, v[132:133] offset:3072
    s_waitcnt lgkmcnt(1)
    buffer_store_dwordx4 v[192:195], v249, s[28:31], s73 offen nt
    s_nop 1
    v_cvt_pk_bf16_f32 v134, v116, v117
    v_cvt_pk_bf16_f32 v135, v118, v119
    ds_write_b64 v247, v[134:135] offset:3072
    ds_read_b128 v[196:199], v248 offset:3072
    s_waitcnt lgkmcnt(0)
    buffer_store_dwordx4 v[196:199], v249, s[28:31], s74 offen nt
L_end:
    s_endpgm
.section .rodata,"a"
.p2align 6
.amdhsa_kernel standalone__layernorm_linear__sampling_kernel
  .amdhsa_next_free_vgpr 512
  .amdhsa_next_free_sgpr 102
  .amdhsa_accum_offset 256
  .amdhsa_group_segment_fixed_size 0
  .amdhsa_kernarg_size 56
  .amdhsa_user_sgpr_count 2
  .amdhsa_user_sgpr_kernarg_segment_ptr 1
  .amdhsa_system_sgpr_workgroup_id_x 1
  .amdhsa_float_denorm_mode_32 3
.end_amdhsa_kernel
```
